```python
import torch

def _softmax(x, axis=-1):
    return torch.softmax(x, dim=axis)
def _gelu(x):
    return torch.nn.functional.gelu(x, approximate="tanh")
def _silu(x):
    return torch.nn.functional.silu(x)
def _sigmoid(x):
    return torch.sigmoid(x)
def _layernorm(x, axis=-1, eps=1e-5):
    m = x.mean(dim=axis, keepdim=True)
    v = x.var(dim=axis, keepdim=True, unbiased=False)
    return (x - m) / torch.sqrt(v + eps)
def _scatter_add(tgt, idx, src, axis=0):
    return tgt.clone().index_add_(axis, idx, src)
def _segment_sum(src, seg, n):
    out = torch.zeros((n,) + src.shape[1:], dtype=src.dtype)
    return out.index_add_(0, seg, src)
def _pad(x, pw):
    flat = tuple(v for pair in reversed(pw) for v in pair)
    return torch.nn.functional.pad(x, flat)

kernel_name = 'sequential_preLN__sliding_block__moe_arch_mod__prompt'

def setup_inputs():

    _w = (lambda a: (lambda t: t.to(torch.bfloat16) if t.is_floating_point() else t)(torch.as_tensor(a)))
    def _A_setup():
        B, S, D = 1, 2048, 640
        return {
            "x": _w((lambda *s: torch.randn(*s, dtype=torch.bfloat16) * 0.05)(B, S, D)),
            "wqkv": _w((lambda *s: torch.randn(*s, dtype=torch.bfloat16) * 0.05)(D, 3 * D)),
            "wo": _w((lambda *s: torch.randn(*s, dtype=torch.bfloat16) * 0.05)(D, D)),
        }
    _A_in = _A_setup()

    def _B_setup():
        B, S, D, F, C = 1, 2048, 640, 1728, 8
        return {
            "x": _w((lambda *s: torch.randn(*s, dtype=torch.bfloat16) * 0.05)(B, S, D)),
            "w_r": _w((lambda *s: torch.randn(*s, dtype=torch.bfloat16) * 0.05)(D)),
            "w_gate": _w((lambda *s: torch.randn(*s, dtype=torch.bfloat16) * 0.05)(D, F)),
            "w_up": _w((lambda *s: torch.randn(*s, dtype=torch.bfloat16) * 0.05)(D, F)),
            "w_down": _w((lambda *s: torch.randn(*s, dtype=torch.bfloat16) * 0.05)(F, D)),
        }
    _B_in = _B_setup()

    return {
        "A_x": _A_in["x"],
        "A_wqkv": _A_in["wqkv"],
        "A_wo": _A_in["wo"],
        "B_x": _B_in["x"],
        "B_w_r": _B_in["w_r"],
        "B_w_gate": _B_in["w_gate"],
        "B_w_up": _B_in["w_up"],
        "B_w_down": _B_in["w_down"],
    }

def reference(A_x, A_wqkv, A_wo, B_x, B_w_r, B_w_gate, B_w_up, B_w_down):
    def _A_ref(x, wqkv, wo):
        B, S, D = x.shape
        H = 32; Dh = D // H; W = 256
        qkv = (lambda x, *d: x.permute(*d))((x @ wqkv).reshape(B, S, 3, H, Dh), 2, 0, 3, 1, 4)
        q, k, v = qkv[0], qkv[1], qkv[2]
        scores = torch.einsum("bhqd,bhkd->bhqk", q, k) * (Dh ** -0.5)
        idx = torch.arange(S)
        mask = (idx[:, None] - idx[None, :] >= 0) & (idx[:, None] - idx[None, :] < W)
        scores = torch.where(mask[None, None], scores, -1e9)
        p = _softmax(scores, axis=-1)
        o = torch.einsum("bhqk,bhkd->bhqd", p, v)
        return (lambda x, *d: x.permute(*d))(o, 0, 2, 1, 3).reshape(B, S, D) @ wo

    def _B_ref(x, w_r, w_gate, w_up, w_down):
        B, S, D = x.shape
        C = 8
        r = x @ w_r
        idx = torch.argsort(-r, axis=-1)[:, :C]
        idx_e = (lambda x, n, axis: torch.repeat_interleave(x, n, dim=axis))(idx.reshape(B, C, 1), D, axis=2)
        x_sel = (lambda x, i, axis: torch.take_along_dim(x, i, dim=axis))(x, idx_e, axis=1)
        g = _silu(x_sel @ w_gate)
        u = x_sel @ w_up
        y = (g * u) @ w_down
        r_sel = _sigmoid((lambda x, i, axis: torch.take_along_dim(x, i, dim=axis))(r, idx, axis=1))
        y = y * r_sel.reshape(B, C, 1)
        b_off = (torch.arange(B) * S).reshape(B, 1)
        flat_idx = (idx + b_off).reshape(B * C)
        zero = (x * 0.0).reshape(B * S, D)
        upd = _scatter_add(zero, flat_idx, y.reshape(B * C, D), axis=0)
        return x + upd.reshape(B, S, D)

    x = A_x
    h = x + _A_ref(_layernorm(x, axis=-1), A_wqkv, A_wo)
    h2 = h + _B_ref(_layernorm(h, axis=-1), B_w_r, B_w_gate, B_w_up, B_w_down)
    return h2
```

```asm
; @launch grid=(256,1,1) block=(512,1,1) lds=163840
.amdgcn_target "amdgcn-amd-amdhsa--gfx950"
.text
.globl sequential_preLN__sliding_block__moe_arch_mod__prompt_kernel
.p2align 8
.type sequential_preLN__sliding_block__moe_arch_mod__prompt_kernel,@function
sequential_preLN__sliding_block__moe_arch_mod__prompt_kernel:
    s_cmp_ge_u32 s2, 256
    s_cbranch_scc1 Lend
    s_load_dwordx2 s[8:9], s[0:1], 0
    s_load_dwordx2 s[12:13], s[0:1], 8
    s_load_dwordx2 s[40:41], s[0:1], 80
    v_lshrrev_b32 v1, 6, v0
    v_and_b32 v255, 63, v0
    v_readfirstlane_b32 s7, v1
    s_mov_b32 s10, 2621440
    s_mov_b32 s11, 0x20000
    s_mov_b32 s14, 2457600
    s_mov_b32 s15, 0x20000
    s_and_b32 s44, s2, 7
    s_lshr_b32 s45, s2, 3
    s_lshr_b32 s3, s44, 1
    s_mul_i32 s3, s3, 30
    s_add_u32 s3, s3, s45
    s_lshr_b32 s47, s3, 3
    s_and_b32 s3, s3, 7
    s_and_b32 s46, s44, 1
    s_lshl3_add_u32 s46, s46, s3
    s_cmp_ge_u32 s45, 30
    s_cselect_b32 s47, 15, s47
    s_and_b32 s52, s7, 3
    s_cmp_lt_u32 s7, 4
    s_cbranch_scc0 LY_start
    s_getpc_b64 s[4:5]
Lpc:
    s_sub_u32 s4, s4, Lpc-sequential_preLN__sliding_block__moe_arch_mod__prompt_kernel
    s_subb_u32 s5, s5, 0
    s_lshl2_add_u32 s3, s45, s52
    s_mul_i32 s3, s3, 384
    v_and_b32 v4, 3, v255
    v_min_u32 v4, 2, v4
    v_lshl_add_u32 v4, v4, 7, s3
    v_min_u32 v4, Lend-sequential_preLN__sliding_block__moe_arch_mod__prompt_kernel, v4
    global_load_dword v254, v4, s[4:5]
    s_branch LX_start
LY_start:
    s_mov_b32 s53, 1
    s_setprio 2
    v_lshrrev_b32 v1, 4, v255
    v_and_b32 v2, 15, v255
    v_lshlrev_b32 v3, 2, v1
    v_xor_b32 v2, v2, v3
    v_mul_u32_u24 v250, 3840, v1
    v_lshl_add_u32 v250, v2, 4, v250
    s_and_b32 s3, s52, 1
    s_lshl_b32 s3, s3, 2
    v_add_u32 v3, s3, v1
    v_and_b32 v2, 7, v255
    v_xor_b32 v2, v2, v3
    v_lshrrev_b32 v1, 3, v255
    v_mul_u32_u24 v251, 1280, v1
    v_lshl_add_u32 v251, v2, 4, v251
    s_lshl_b32 s4, s47, 8
    s_mul_i32 s3, s52, 61440
    s_add_u32 s4, s4, s3
    s_mul_i32 s5, s46, 81920
    s_mul_i32 s3, s52, 10240
    s_add_u32 s5, s5, s3
    s_lshl_b32 s65, s52, 12
    s_lshl_b32 s66, s52, 10
    s_add_u32 s66, s66, 49152
    s_bitcmp1_b32 s46, 0
    s_cselect_b32 s56, 5, 0
    s_waitcnt lgkmcnt(0)
    s_cmp_eq_u32 s47, 15
    s_cbranch_scc1 LY_skipA
    s_mul_i32 s68, s56, 245760
    s_add_u32 m0, s65, 0
    s_add_u32 s68, s68, s4
    buffer_load_dwordx4 v250, s[12:15], s68 offen lds
    s_add_u32 m0, s65, 1024
    s_add_u32 s68, s68, 15360
    buffer_load_dwordx4 v250, s[12:15], s68 offen lds
    s_add_u32 m0, s65, 2048
    s_add_u32 s68, s68, 15360
    buffer_load_dwordx4 v250, s[12:15], s68 offen lds
    s_add_u32 m0, s65, 3072
    s_add_u32 s68, s68, 15360
    buffer_load_dwordx4 v250, s[12:15], s68 offen lds
    s_lshl_b32 s68, s56, 7
    s_add_u32 s68, s68, s5
    s_add_u32 m0, s66, 0
    s_add_u32 s69, s68, 40960
    buffer_load_dwordx4 v251, s[8:11], s68 offen lds
    s_add_u32 m0, s66, 4096
    s_add_u32 s56, s56, 1
    s_cmp_eq_u32 s56, 10
    s_cselect_b32 s56, 0, s56
    buffer_load_dwordx4 v251, s[8:11], s69 offen lds
    s_load_dword s6, s[40:41], 0
    s_load_dwordx2 s[32:33], s[0:1], 56
    s_load_dwordx2 s[36:37], s[0:1], 64
    s_load_dwordx2 s[16:17], s[0:1], 16
    s_load_dwordx2 s[20:21], s[0:1], 32
    s_load_dwordx2 s[24:25], s[0:1], 40
    s_load_dwordx2 s[28:29], s[0:1], 48
    s_mov_b32 s42, 268435456
    s_mov_b32 s43, 0x20000
    s_mov_b32 s18, 819200
    s_mov_b32 s19, 0x20000
    s_mov_b32 s22, 1280
    s_mov_b32 s23, 0x20000
    s_mov_b32 s26, 2211840
    s_mov_b32 s27, 0x20000
    s_mov_b32 s30, 2211840
    s_mov_b32 s31, 0x20000
    s_mov_b32 s34, 2211840
    s_mov_b32 s35, 0x20000
    s_mov_b32 s38, 2621440
    s_mov_b32 s39, 0x20000
    s_lshr_b32 s67, s45, 4
    s_and_b32 s3, s44, 1
    s_lshl1_add_u32 s67, s67, s3
    s_lshr_b32 s3, s44, 1
    s_lshl2_add_u32 s67, s67, s3
    s_and_b32 s3, s45, 15
    s_lshl4_add_u32 s67, s67, s3
    s_lshl2_add_u32 s67, s67, s52
    s_lshl_b32 s67, s67, 1
    v_lshrrev_b32 v1, 5, v255
    v_and_b32 v2, 31, v255
    v_mul_u32_u24 v7, 1280, v1
    v_lshl_add_u32 v8, v2, 3, v7
    v_lshl_add_u32 v7, v2, 4, v7
    s_mul_i32 s3, s67, 1280
    buffer_load_dwordx4 v[20:23], v7, s[8:11], s3 offen
    buffer_load_dwordx4 v[24:27], v7, s[8:11], s3 offen offset:512
    buffer_load_dwordx2 v[28:29], v8, s[8:11], s3 offen offset:1024
    s_and_b32 s3, s45, 3
    s_lshl2_add_u32 s48, s44, s3
    s_lshr_b32 s49, s45, 2
    s_lshl_b32 s51, s44, 4
    s_sub_u32 s51, s51, 16
    s_lshl_b32 s3, s44, 3
    s_lshl_b32 s60, s44, 2
    s_sub_u32 s60, s60, 8
    s_sub_u32 s61, s3, 8
    s_cmp_lt_u32 s44, 2
    s_cselect_b32 s51, s3, s51
    s_cselect_b32 s60, s61, s60
    s_cselect_b32 s3, 8, 16
    s_cselect_b32 s61, 16, 20
    s_cmp_lt_u32 s45, s61
    s_cselect_b32 s50, 1, 2
    s_cmp_lt_u32 s45, s3
    s_cselect_b32 s51, s51, s60
    s_cselect_b32 s50, 0, s50
    s_add_u32 s51, s51, s45
    s_cmp_ge_u32 s51, 108
    s_cselect_b32 s50, 2, s50
    s_mul_i32 s60, s49, 160
    s_xor_b32 s3, s53, 0
    s_lshl_b32 s3, s3, 5
    s_add_u32 s3, s3, s48
    s_lshl2_add_u32 s61, s3, s52
    s_mul_i32 s61, s61, 10240
    s_add_u32 s61, s61, s60
    s_lshl_b32 s62, s48, 13
    s_add_u32 s62, s62, 1048576
    s_mul_i32 s64, s52, 204800
    s_add_u32 s64, s64, s60
    s_mul_i32 s63, s52, 21504
    s_add_u32 s63, s63, 74752
    v_lshrrev_b32 v1, 4, v255
    v_bfe_u32 v2, v255, 2, 2
    v_lshl_add_u32 v2, v1, 3, v2
    v_mul_u32_u24 v2, 160, v2
    v_and_b32 v3, 3, v255
    v_lshl_add_u32 v2, v3, 3, v2
    v_add_u32 v190, s63, v2
    v_and_b32 v3, 15, v255
    v_mul_u32_u24 v2, 32768, v1
    v_lshl_add_u32 v191, v3, 4, v2
    v_lshl_add_u32 v192, v3, 3, v2
    v_and_b32 v193, 7, v255
    v_min_u32 v193, 4, v193
    v_lshlrev_b32 v193, 7, v193
    v_and_b32 v2, 8, v255
    v_lshl_add_u32 v193, v2, 14, v193
    v_bfe_u32 v192, v255, 1, 2
    v_mul_u32_u24 v192, 163840, v192
    v_lshl_add_u32 v192, v2, 11, v192
    v_and_b32 v2, 1, v255
    v_lshl_add_u32 v192, v2, 3, v192
    v_mul_u32_u24 v3, 336, v3
    v_lshl_add_u32 v3, v1, 4, v3
    v_add_u32 v194, s63, v3
    v_lshlrev_b32 v252, 4, v255
    v_mov_b32 v1, v255
    v_mul_u32_u24 v2, 6554, v1
    v_lshrrev_b32 v2, 16, v2
    v_mul_u32_u24 v3, 10, v2
    v_sub_u32 v3, v1, v3
    v_mul_u32_u24 v2, 1280, v2
    v_lshl_add_u32 v180, v3, 4, v2
    v_add_u32 v1, 64, v1
    v_mul_u32_u24 v2, 6554, v1
    v_lshrrev_b32 v2, 16, v2
    v_mul_u32_u24 v3, 10, v2
    v_sub_u32 v3, v1, v3
    v_mul_u32_u24 v2, 1280, v2
    v_lshl_add_u32 v181, v3, 4, v2
    v_add_u32 v1, 64, v1
    v_mul_u32_u24 v2, 6554, v1
    v_lshrrev_b32 v2, 16, v2
    v_mul_u32_u24 v3, 10, v2
    v_sub_u32 v3, v1, v3
    v_mul_u32_u24 v2, 1280, v2
    v_lshl_add_u32 v182, v3, 4, v2
    v_add_u32 v1, 64, v1
    v_mul_u32_u24 v2, 6554, v1
    v_lshrrev_b32 v2, 16, v2
    v_mul_u32_u24 v3, 10, v2
    v_sub_u32 v3, v1, v3
    v_mul_u32_u24 v2, 1280, v2
    v_lshl_add_u32 v183, v3, 4, v2
    v_add_u32 v1, 64, v1
    v_mul_u32_u24 v2, 6554, v1
    v_lshrrev_b32 v2, 16, v2
    v_mul_u32_u24 v3, 10, v2
    v_sub_u32 v3, v1, v3
    v_mul_u32_u24 v2, 1280, v2
    v_lshl_add_u32 v184, v3, 4, v2
    s_add_u32 s68, s49, 0
    s_and_b32 s73, s48, 1
    s_lshr_b32 s69, s48, 1
    s_mul_i32 s69, s69, 5
    s_add_u32 s71, s69, 2
    s_mul_i32 s3, s73, 3
    s_add_u32 s70, s69, s3
    s_lshl1_add_u32 s69, s73, s69
    s_lshl_b32 s72, s68, 1
    s_sub_u32 s72, s72, 4
    s_lshl2_add_u32 s55, s68, s52
    s_lshl_b32 s3, s55, 9
    s_add_u32 s3, s3, 16777216
    s_mul_i32 s57, s70, 32768
    s_add_u32 s57, s57, s3
    s_mul_i32 s58, s71, 32768
    s_add_u32 s58, s58, s3
    s_lshl3_add_u32 s58, s73, s58
    s_add_u32 s55, s55, 1
    s_mov_b32 s54, 0
    s_lshr_b32 s3, s52, 1
    s_add_u32 s3, s3, 4
    s_sub_u32 s3, s3, s52
    v_bfe_u32 v1, v255, 2, 1
    v_mul_u32_u24 v1, s3, v1
    s_add_u32 s3, s72, s52
    v_add_u32 v1, s3, v1
    v_max_i32 v1, 0, v1
    s_and_b32 s3, s52, 1
    s_lshl_b32 s3, s3, 4
    s_add_u32 s3, s3, 0x19
    v_and_b32 v2, 6, v255
    v_lshrrev_b32 v3, v2, s3
    v_and_b32 v3, 3, v3
    v_mul_u32_u24 v3, 80, v3
    v_and_b32 v2, 1, v255
    v_lshl_add_u32 v3, v2, 1, v3
    v_add_u32 v3, s69, v3
    v_lshrrev_b32 v3, 2, v3
    v_lshl_add_u32 v1, v1, 6, v3
    v_lshlrev_b32 v157, 7, v1
    v_lshrrev_b32 v1, 5, v255
    v_and_b32 v2, 31, v255
    s_lshl_b32 s3, s52, 9
    s_add_u32 s3, s3, 0
    v_lshl_add_u32 v153, v2, 4, s3
    v_mul_u32_u24 v3, 6208, v1
    v_add_u32 v152, v153, v3
    v_add_u32 v153, 12416, v153
    v_lshl_add_u32 v153, s73, 3, v153
    v_lshlrev_b32 v3, 2, v1
    v_sub_u32 v7, v2, v3
    v_bfe_u32 v4, v255, 2, 2
    v_add_u32 v3, v3, v4
    v_lshlrev_b32 v3, 4, v3
    v_and_b32 v4, 1, v255
    v_mul_u32_u24 v4, 6208, v4
    v_bfe_u32 v5, v255, 1, 1
    v_lshl_add_u32 v4, v5, 3, v4
    s_lshl_b32 s74, s73, 3
    s_add_u32 s74, s74, 12416
    v_mov_b32 v5, s74
    v_and_b32 v6, 16, v255
    v_cmp_ne_u32 vcc, 0, v6
    s_nop 1
    v_cndmask_b32 v4, v4, v5, vcc
    s_add_u32 s3, s3, 22720
    v_add3_u32 v4, v4, v3, s3
    v_add_u32 v5, 161920, v3
    v_and_b32 v6, 19, v255
    v_cmp_lt_u32 vcc, 16, v6
    s_nop 1
    v_cndmask_b32 v156, v4, v5, vcc
    v_mov_b32 v4, 512
    v_cndmask_b32 v155, v4, 0, vcc
    v_lshlrev_b32 v104, 4, v2
    v_mul_u32_u24 v158, 32768, v1
    v_add_u32 v158, v158, v104
    v_lshlrev_b32 v159, 4, v2
    v_lshlrev_b32 v105, 4, v255
    v_mov_b32 v4, 0xff800000
    s_cmp_lt_u32 s55, 9
    s_cselect_b32 s3, 0, -1
    v_mov_b32 v5, 0xffff
    v_subrev_u32 v64, 0, v7
    v_ashrrev_i32 v64, 31, v64
    v_mov_b32 v48, 0
    v_subrev_u32 v65, 1, v7
    v_ashrrev_i32 v65, 31, v65
    v_mov_b32 v49, 0
    v_subrev_u32 v66, 2, v7
    v_ashrrev_i32 v66, 31, v66
    v_mov_b32 v50, 0
    v_subrev_u32 v67, 3, v7
    v_ashrrev_i32 v67, 31, v67
    v_mov_b32 v51, 0
    v_subrev_u32 v68, 8, v7
    v_ashrrev_i32 v68, 31, v68
    v_mov_b32 v52, 0
    v_subrev_u32 v69, 9, v7
    v_ashrrev_i32 v69, 31, v69
    v_mov_b32 v53, 0
    v_subrev_u32 v70, 10, v7
    v_ashrrev_i32 v70, 31, v70
    v_mov_b32 v54, 0
    v_subrev_u32 v71, 11, v7
    v_ashrrev_i32 v71, 31, v71
    v_mov_b32 v55, 0
    v_subrev_u32 v72, 16, v7
    v_ashrrev_i32 v72, 31, v72
    v_mov_b32 v56, 0
    v_subrev_u32 v73, 17, v7
    v_ashrrev_i32 v73, 31, v73
    v_mov_b32 v57, 0
    v_subrev_u32 v74, 18, v7
    v_ashrrev_i32 v74, 31, v74
    v_mov_b32 v58, 0
    v_subrev_u32 v75, 19, v7
    v_ashrrev_i32 v75, 31, v75
    v_mov_b32 v59, 0
    v_subrev_u32 v76, 24, v7
    v_ashrrev_i32 v76, 31, v76
    v_mov_b32 v60, 0
    v_subrev_u32 v77, 25, v7
    v_ashrrev_i32 v77, 31, v77
    v_mov_b32 v61, 0
    v_subrev_u32 v78, 26, v7
    v_ashrrev_i32 v78, 31, v78
    v_mov_b32 v62, 0
    v_subrev_u32 v79, 27, v7
    v_ashrrev_i32 v79, 31, v79
    v_mov_b32 v63, 0
    v_bitop3_b32 v88, v5, v64, v65 bitop3:0xca
    v_not_b32 v80, v88
    v_and_b32 v88, s3, v88
    v_bitop3_b32 v89, v5, v66, v67 bitop3:0xca
    v_not_b32 v81, v89
    v_and_b32 v89, s3, v89
    v_bitop3_b32 v90, v5, v68, v69 bitop3:0xca
    v_not_b32 v82, v90
    v_and_b32 v90, s3, v90
    v_bitop3_b32 v91, v5, v70, v71 bitop3:0xca
    v_not_b32 v83, v91
    v_and_b32 v91, s3, v91
    v_bitop3_b32 v92, v5, v72, v73 bitop3:0xca
    v_not_b32 v84, v92
    v_and_b32 v92, s3, v92
    v_bitop3_b32 v93, v5, v74, v75 bitop3:0xca
    v_not_b32 v85, v93
    v_and_b32 v93, s3, v93
    v_bitop3_b32 v94, v5, v76, v77 bitop3:0xca
    v_not_b32 v86, v94
    v_and_b32 v94, s3, v94
    v_bitop3_b32 v95, v5, v78, v79 bitop3:0xca
    v_not_b32 v87, v95
    v_and_b32 v95, s3, v95
    s_mul_i32 s68, s56, 245760
    s_add_u32 m0, s65, 16384
    s_add_u32 s68, s68, s4
    buffer_load_dwordx4 v250, s[12:15], s68 offen lds
    s_add_u32 m0, s65, 17408
    s_add_u32 s68, s68, 15360
    buffer_load_dwordx4 v250, s[12:15], s68 offen lds
    s_add_u32 m0, s65, 18432
    s_add_u32 s68, s68, 15360
    buffer_load_dwordx4 v250, s[12:15], s68 offen lds
    s_add_u32 m0, s65, 19456
    s_add_u32 s68, s68, 15360
    buffer_load_dwordx4 v250, s[12:15], s68 offen lds
    s_lshl_b32 s68, s56, 7
    s_add_u32 s68, s68, s5
    s_add_u32 m0, s66, 8192
    s_add_u32 s69, s68, 40960
    buffer_load_dwordx4 v251, s[8:11], s68 offen lds
    s_add_u32 m0, s66, 12288
    s_add_u32 s56, s56, 1
    s_cmp_eq_u32 s56, 10
    s_cselect_b32 s56, 0, s56
    buffer_load_dwordx4 v251, s[8:11], s69 offen lds
    s_waitcnt vmcnt(9)
    s_barrier
    s_mul_i32 s68, s56, 245760
    s_add_u32 m0, s65, 32768
    s_add_u32 s68, s68, s4
    buffer_load_dwordx4 v250, s[12:15], s68 offen lds
    s_add_u32 m0, s65, 33792
    s_add_u32 s68, s68, 15360
    buffer_load_dwordx4 v250, s[12:15], s68 offen lds
    s_add_u32 m0, s65, 34816
    s_add_u32 s68, s68, 15360
    buffer_load_dwordx4 v250, s[12:15], s68 offen lds
    s_add_u32 m0, s65, 35840
    s_add_u32 s68, s68, 15360
    buffer_load_dwordx4 v250, s[12:15], s68 offen lds
    s_lshl_b32 s68, s56, 7
    s_add_u32 s68, s68, s5
    s_add_u32 m0, s66, 16384
    s_add_u32 s69, s68, 40960
    buffer_load_dwordx4 v251, s[8:11], s68 offen lds
    s_add_u32 m0, s66, 20480
    s_add_u32 s56, s56, 1
    s_cmp_eq_u32 s56, 10
    s_cselect_b32 s56, 0, s56
    buffer_load_dwordx4 v251, s[8:11], s69 offen lds
    s_waitcnt lgkmcnt(0) vmcnt(12)
    s_mul_i32 s6, s6, 1664525
    s_add_u32 s6, s6, 1013904223
    s_bitset0_b32 s6, 31
    v_lshlrev_b32 v120, 16, v20
    v_and_b32 v121, 0xffff0000, v20
    v_lshlrev_b32 v122, 16, v21
    v_and_b32 v123, 0xffff0000, v21
    v_lshlrev_b32 v124, 16, v22
    v_and_b32 v125, 0xffff0000, v22
    v_lshlrev_b32 v126, 16, v23
    v_and_b32 v127, 0xffff0000, v23
    v_lshlrev_b32 v128, 16, v24
    v_and_b32 v129, 0xffff0000, v24
    v_lshlrev_b32 v130, 16, v25
    v_and_b32 v131, 0xffff0000, v25
    v_lshlrev_b32 v132, 16, v26
    v_and_b32 v133, 0xffff0000, v26
    v_lshlrev_b32 v134, 16, v27
    v_and_b32 v135, 0xffff0000, v27
    v_lshlrev_b32 v136, 16, v28
    v_and_b32 v137, 0xffff0000, v28
    v_lshlrev_b32 v138, 16, v29
    v_and_b32 v139, 0xffff0000, v29
    v_add_f32 v10, v120, v121
    v_add_f32 v11, v122, v123
    v_add_f32 v10, v10, v124
    v_add_f32 v11, v11, v125
    v_add_f32 v10, v10, v126
    v_add_f32 v11, v11, v127
    v_add_f32 v10, v10, v128
    v_add_f32 v11, v11, v129
    v_add_f32 v10, v10, v130
    v_add_f32 v11, v11, v131
    v_add_f32 v10, v10, v132
    v_add_f32 v11, v11, v133
    v_add_f32 v10, v10, v134
    v_add_f32 v11, v11, v135
    v_add_f32 v10, v10, v136
    v_add_f32 v11, v11, v137
    v_add_f32 v10, v10, v138
    v_add_f32 v11, v11, v139
    v_add_f32 v10, v10, v11
    s_nop 1
    v_add_f32_dpp v10, v10, v10 quad_perm:[1,0,3,2] row_mask:0xf bank_mask:0xf
    s_nop 1
    v_add_f32_dpp v10, v10, v10 quad_perm:[2,3,0,1] row_mask:0xf bank_mask:0xf
    s_nop 1
    v_add_f32_dpp v10, v10, v10 row_half_mirror row_mask:0xf bank_mask:0xf
    s_nop 1
    v_add_f32_dpp v10, v10, v10 row_mirror row_mask:0xf bank_mask:0xf
    v_mov_b32 v11, v10
    s_nop 1
    v_permlane16_swap_b32 v10, v11
    s_waitcnt vmcnt(6)
    s_barrier
    s_mul_i32 s68, s56, 245760
    s_add_u32 m0, s65, 0
    s_add_u32 s68, s68, s4
    buffer_load_dwordx4 v250, s[12:15], s68 offen lds
    s_add_u32 m0, s65, 1024
    s_add_u32 s68, s68, 15360
    buffer_load_dwordx4 v250, s[12:15], s68 offen lds
    s_add_u32 m0, s65, 2048
    s_add_u32 s68, s68, 15360
    buffer_load_dwordx4 v250, s[12:15], s68 offen lds
    s_add_u32 m0, s65, 3072
    s_add_u32 s68, s68, 15360
    buffer_load_dwordx4 v250, s[12:15], s68 offen lds
    s_lshl_b32 s68, s56, 7
    s_add_u32 s68, s68, s5
    s_add_u32 m0, s66, 0
    s_add_u32 s69, s68, 40960
    buffer_load_dwordx4 v251, s[8:11], s68 offen lds
    s_add_u32 m0, s66, 4096
    s_add_u32 s56, s56, 1
    s_cmp_eq_u32 s56, 10
    s_cselect_b32 s56, 0, s56
    buffer_load_dwordx4 v251, s[8:11], s69 offen lds
    v_add_f32 v10, v10, v11
    v_mul_f32 v10, 0x3acccccd, v10
    v_sub_f32 v120, v120, v10
    v_sub_f32 v121, v121, v10
    v_sub_f32 v122, v122, v10
    v_sub_f32 v123, v123, v10
    v_sub_f32 v124, v124, v10
    v_sub_f32 v125, v125, v10
    v_sub_f32 v126, v126, v10
    v_sub_f32 v127, v127, v10
    v_sub_f32 v128, v128, v10
    v_sub_f32 v129, v129, v10
    v_sub_f32 v130, v130, v10
    v_sub_f32 v131, v131, v10
    v_sub_f32 v132, v132, v10
    v_sub_f32 v133, v133, v10
    v_sub_f32 v134, v134, v10
    v_sub_f32 v135, v135, v10
    v_sub_f32 v136, v136, v10
    v_sub_f32 v137, v137, v10
    v_sub_f32 v138, v138, v10
    v_sub_f32 v139, v139, v10
    v_mul_f32 v11, v120, v120
    v_mul_f32 v12, v121, v121
    v_fmac_f32 v11, v122, v122
    v_fmac_f32 v12, v123, v123
    v_fmac_f32 v11, v124, v124
    v_fmac_f32 v12, v125, v125
    v_fmac_f32 v11, v126, v126
    v_fmac_f32 v12, v127, v127
    v_fmac_f32 v11, v128, v128
    v_fmac_f32 v12, v129, v129
    v_fmac_f32 v11, v130, v130
    v_fmac_f32 v12, v131, v131
    v_fmac_f32 v11, v132, v132
    v_fmac_f32 v12, v133, v133
    v_fmac_f32 v11, v134, v134
    v_fmac_f32 v12, v135, v135
    v_fmac_f32 v11, v136, v136
    v_fmac_f32 v12, v137, v137
    v_fmac_f32 v11, v138, v138
    v_fmac_f32 v12, v139, v139
    v_add_f32 v11, v11, v12
    s_nop 1
    v_add_f32_dpp v11, v11, v11 quad_perm:[1,0,3,2] row_mask:0xf bank_mask:0xf
    s_nop 1
    v_add_f32_dpp v11, v11, v11 quad_perm:[2,3,0,1] row_mask:0xf bank_mask:0xf
    s_waitcnt vmcnt(6)
    s_barrier
    s_mul_i32 s68, s56, 245760
    s_add_u32 m0, s65, 16384
    s_add_u32 s68, s68, s4
    buffer_load_dwordx4 v250, s[12:15], s68 offen lds
    s_add_u32 m0, s65, 17408
    s_add_u32 s68, s68, 15360
    buffer_load_dwordx4 v250, s[12:15], s68 offen lds
    s_add_u32 m0, s65, 18432
    s_add_u32 s68, s68, 15360
    buffer_load_dwordx4 v250, s[12:15], s68 offen lds
    s_add_u32 m0, s65, 19456
    s_add_u32 s68, s68, 15360
    buffer_load_dwordx4 v250, s[12:15], s68 offen lds
    s_lshl_b32 s68, s56, 7
    s_add_u32 s68, s68, s5
    s_add_u32 m0, s66, 8192
    s_add_u32 s69, s68, 40960
    buffer_load_dwordx4 v251, s[8:11], s68 offen lds
    s_add_u32 m0, s66, 12288
    s_add_u32 s56, s56, 1
    s_cmp_eq_u32 s56, 10
    s_cselect_b32 s56, 0, s56
    buffer_load_dwordx4 v251, s[8:11], s69 offen lds
    v_add_f32_dpp v11, v11, v11 row_half_mirror row_mask:0xf bank_mask:0xf
    s_nop 1
    v_add_f32_dpp v11, v11, v11 row_mirror row_mask:0xf bank_mask:0xf
    v_mov_b32 v12, v11
    s_nop 1
    v_permlane16_swap_b32 v11, v12
    v_add_f32 v11, v11, v12
    v_mul_f32 v11, 0x3acccccd, v11
    v_cvt_pk_bf16_f32 v11, v11, v11
    v_lshlrev_b32 v11, 16, v11
    v_add_f32 v11, 0x3727c5ac, v11
    v_cvt_pk_bf16_f32 v11, v11, v11
    v_lshlrev_b32 v11, 16, v11
    v_sqrt_f32 v11, v11
    v_cvt_pk_bf16_f32 v13, v10, v10
    v_lshlrev_b32 v13, 16, v13
    v_cvt_pk_bf16_f32 v11, v11, v11
    v_lshlrev_b32 v11, 16, v11
    v_rcp_f32 v12, v11
    v_mov_b32 v14, s6
    v_mov_b32 v15, s6
    v_lshrrev_b32 v9, 1, v255
    s_lshl_b32 s0, s67, 4
    s_add_u32 s0, s0, 688128
    s_mov_b32 exec_lo, 0x1
    s_mov_b32 exec_hi, 0x1
    buffer_store_dwordx4 v[12:15], v9, s[40:43], s0 offen sc1
    s_mov_b64 exec, -1
    s_waitcnt vmcnt(7)
    s_barrier
    s_mul_i32 s68, s56, 245760
    s_add_u32 m0, s65, 32768
    s_add_u32 s68, s68, s4
    buffer_load_dwordx4 v250, s[12:15], s68 offen lds
    s_add_u32 m0, s65, 33792
    s_add_u32 s68, s68, 15360
    buffer_load_dwordx4 v250, s[12:15], s68 offen lds
    s_add_u32 m0, s65, 34816
    s_add_u32 s68, s68, 15360
    buffer_load_dwordx4 v250, s[12:15], s68 offen lds
    s_add_u32 m0, s65, 35840
    s_add_u32 s68, s68, 15360
    buffer_load_dwordx4 v250, s[12:15], s68 offen lds
    s_lshl_b32 s68, s56, 7
    s_add_u32 s68, s68, s5
    s_add_u32 m0, s66, 16384
    s_add_u32 s69, s68, 40960
    buffer_load_dwordx4 v251, s[8:11], s68 offen lds
    s_add_u32 m0, s66, 20480
    s_add_u32 s56, s56, 1
    s_cmp_eq_u32 s56, 10
    s_cselect_b32 s56, 0, s56
    buffer_load_dwordx4 v251, s[8:11], s69 offen lds
    s_waitcnt vmcnt(7)
    s_barrier
    s_mul_i32 s68, s56, 245760
    s_add_u32 m0, s65, 0
    s_add_u32 s68, s68, s4
    buffer_load_dwordx4 v250, s[12:15], s68 offen lds
    s_add_u32 m0, s65, 1024
    s_add_u32 s68, s68, 15360
    buffer_load_dwordx4 v250, s[12:15], s68 offen lds
    s_add_u32 m0, s65, 2048
    s_add_u32 s68, s68, 15360
    buffer_load_dwordx4 v250, s[12:15], s68 offen lds
    s_add_u32 m0, s65, 3072
    s_add_u32 s68, s68, 15360
    buffer_load_dwordx4 v250, s[12:15], s68 offen lds
    s_lshl_b32 s68, s56, 7
    s_add_u32 s68, s68, s5
    s_add_u32 m0, s66, 0
    s_add_u32 s69, s68, 40960
    buffer_load_dwordx4 v251, s[8:11], s68 offen lds
    s_add_u32 m0, s66, 4096
    s_add_u32 s56, s56, 1
    s_cmp_eq_u32 s56, 10
    s_cselect_b32 s56, 0, s56
    buffer_load_dwordx4 v251, s[8:11], s69 offen lds
    s_waitcnt vmcnt(6)
    s_barrier
    s_mul_i32 s68, s56, 245760
    s_add_u32 m0, s65, 16384
    s_add_u32 s68, s68, s4
    buffer_load_dwordx4 v250, s[12:15], s68 offen lds
    s_add_u32 m0, s65, 17408
    s_add_u32 s68, s68, 15360
    buffer_load_dwordx4 v250, s[12:15], s68 offen lds
    s_add_u32 m0, s65, 18432
    s_add_u32 s68, s68, 15360
    buffer_load_dwordx4 v250, s[12:15], s68 offen lds
    s_add_u32 m0, s65, 19456
    s_add_u32 s68, s68, 15360
    buffer_load_dwordx4 v250, s[12:15], s68 offen lds
    s_lshl_b32 s68, s56, 7
    s_add_u32 s68, s68, s5
    s_add_u32 m0, s66, 8192
    s_add_u32 s69, s68, 40960
    buffer_load_dwordx4 v251, s[8:11], s68 offen lds
    s_add_u32 m0, s66, 12288
    s_add_u32 s56, s56, 1
    s_cmp_eq_u32 s56, 10
    s_cselect_b32 s56, 0, s56
    buffer_load_dwordx4 v251, s[8:11], s69 offen lds
    s_waitcnt vmcnt(6)
    s_barrier
    s_mul_i32 s68, s56, 245760
    s_add_u32 m0, s65, 32768
    s_add_u32 s68, s68, s4
    buffer_load_dwordx4 v250, s[12:15], s68 offen lds
    s_add_u32 m0, s65, 33792
    s_add_u32 s68, s68, 15360
    buffer_load_dwordx4 v250, s[12:15], s68 offen lds
    s_add_u32 m0, s65, 34816
    s_add_u32 s68, s68, 15360
    buffer_load_dwordx4 v250, s[12:15], s68 offen lds
    s_add_u32 m0, s65, 35840
    s_add_u32 s68, s68, 15360
    buffer_load_dwordx4 v250, s[12:15], s68 offen lds
    s_lshl_b32 s68, s56, 7
    s_add_u32 s68, s68, s5
    s_add_u32 m0, s66, 16384
    s_add_u32 s69, s68, 40960
    buffer_load_dwordx4 v251, s[8:11], s68 offen lds
    s_add_u32 m0, s66, 20480
    s_add_u32 s56, s56, 1
    s_cmp_eq_u32 s56, 10
    s_cselect_b32 s56, 0, s56
    buffer_load_dwordx4 v251, s[8:11], s69 offen lds
    s_and_b32 s3, s52, 1
    s_lshl_b32 s68, s3, 10
    s_add_u32 m0, s68, 155648
    s_lshl_b32 s3, s3, 14
    s_lshl_b32 s68, s46, 10
    s_add_u32 s3, s3, s68
    s_add_u32 s3, s3, 688128
    buffer_load_dwordx4 v252, s[40:43], s3 offen sc1 lds
    s_waitcnt vmcnt(7)
    s_barrier
    s_mul_i32 s68, s56, 245760
    s_add_u32 m0, s65, 0
    s_add_u32 s68, s68, s4
    buffer_load_dwordx4 v250, s[12:15], s68 offen lds
    s_add_u32 m0, s65, 1024
    s_add_u32 s68, s68, 15360
    buffer_load_dwordx4 v250, s[12:15], s68 offen lds
    s_add_u32 m0, s65, 2048
    s_add_u32 s68, s68, 15360
    buffer_load_dwordx4 v250, s[12:15], s68 offen lds
    s_add_u32 m0, s65, 3072
    s_add_u32 s68, s68, 15360
    buffer_load_dwordx4 v250, s[12:15], s68 offen lds
    s_lshl_b32 s68, s56, 7
    s_add_u32 s68, s68, s5
    s_add_u32 m0, s66, 0
    s_add_u32 s69, s68, 40960
    buffer_load_dwordx4 v251, s[8:11], s68 offen lds
    s_add_u32 m0, s66, 4096
    s_add_u32 s56, s56, 1
    s_cmp_eq_u32 s56, 10
    s_cselect_b32 s56, 0, s56
    buffer_load_dwordx4 v251, s[8:11], s69 offen lds
    s_waitcnt vmcnt(7)
    s_barrier
    s_lshl_b32 s68, s56, 7
    s_add_u32 s68, s68, s5
    s_add_u32 s68, s68, 1310720
    s_add_u32 m0, s66, 24576
    s_add_u32 s56, s56, 1
    s_cmp_eq_u32 s56, 10
    s_cselect_b32 s56, 0, s56
    buffer_load_dwordx4 v251, s[8:11], s68 offen lds
    s_lshl_b32 s68, s56, 7
    s_add_u32 s68, s68, s5
    s_add_u32 s68, s68, 1310720
    s_add_u32 m0, s66, 32768
    s_add_u32 s56, s56, 1
    s_cmp_eq_u32 s56, 10
    s_cselect_b32 s56, 0, s56
    buffer_load_dwordx4 v251, s[8:11], s68 offen lds
    s_lshl_b32 s68, s56, 7
    s_add_u32 s68, s68, s5
    s_add_u32 s68, s68, 1310720
    s_add_u32 m0, s66, 40960
    s_add_u32 s56, s56, 1
    s_cmp_eq_u32 s56, 10
    s_cselect_b32 s56, 0, s56
    buffer_load_dwordx4 v251, s[8:11], s68 offen lds
    s_lshl_b32 s68, s56, 7
    s_add_u32 s68, s68, s5
    s_add_u32 s68, s68, 1310720
    s_add_u32 m0, s66, 49152
    s_add_u32 s56, s56, 1
    s_cmp_eq_u32 s56, 10
    s_cselect_b32 s56, 0, s56
    buffer_load_dwordx4 v251, s[8:11], s68 offen lds
    s_lshl_b32 s68, s56, 7
    s_add_u32 s68, s68, s5
    s_add_u32 s68, s68, 1310720
    s_add_u32 m0, s66, 57344
    s_add_u32 s56, s56, 1
    s_cmp_eq_u32 s56, 10
    s_cselect_b32 s56, 0, s56
    buffer_load_dwordx4 v251, s[8:11], s68 offen lds
    s_lshl_b32 s68, s56, 7
    s_add_u32 s68, s68, s5
    s_add_u32 s68, s68, 1310720
    s_add_u32 m0, s66, 65536
    s_add_u32 s56, s56, 1
    s_cmp_eq_u32 s56, 10
    s_cselect_b32 s56, 0, s56
    buffer_load_dwordx4 v251, s[8:11], s68 offen lds
    s_waitcnt vmcnt(6)
    s_barrier
    s_lshl_b32 s68, s56, 7
    s_add_u32 s68, s68, s5
    s_add_u32 s68, s68, 1310720
    s_add_u32 m0, s66, 73728
    s_add_u32 s56, s56, 1
    s_cmp_eq_u32 s56, 10
    s_cselect_b32 s56, 0, s56
    buffer_load_dwordx4 v251, s[8:11], s68 offen lds
    s_lshl_b32 s68, s56, 7
    s_add_u32 s68, s68, s5
    s_add_u32 s68, s68, 1310720
    s_add_u32 m0, s66, 81920
    s_add_u32 s56, s56, 1
    s_cmp_eq_u32 s56, 10
    s_cselect_b32 s56, 0, s56
    buffer_load_dwordx4 v251, s[8:11], s68 offen lds
    s_lshl_b32 s68, s56, 7
    s_add_u32 s68, s68, s5
    s_add_u32 s68, s68, 1310720
    s_add_u32 m0, s66, 90112
    s_add_u32 s56, s56, 1
    s_cmp_eq_u32 s56, 10
    s_cselect_b32 s56, 0, s56
    buffer_load_dwordx4 v251, s[8:11], s68 offen lds
    s_lshl_b32 s68, s56, 7
    s_add_u32 s68, s68, s5
    s_add_u32 s68, s68, 1310720
    s_add_u32 m0, s66, 98304
    s_add_u32 s56, s56, 1
    s_cmp_eq_u32 s56, 10
    s_cselect_b32 s56, 0, s56
    buffer_load_dwordx4 v251, s[8:11], s68 offen lds
    s_lshl_b32 s68, s56, 7
    s_add_u32 s68, s68, s5
    s_add_u32 s68, s68, 1351680
    s_add_u32 m0, s66, 28672
    s_add_u32 s56, s56, 1
    s_cmp_eq_u32 s56, 10
    s_cselect_b32 s56, 0, s56
    buffer_load_dwordx4 v251, s[8:11], s68 offen lds
    s_lshl_b32 s68, s56, 7
    s_add_u32 s68, s68, s5
    s_add_u32 s68, s68, 1351680
    s_add_u32 m0, s66, 36864
    s_add_u32 s56, s56, 1
    s_cmp_eq_u32 s56, 10
    s_cselect_b32 s56, 0, s56
    buffer_load_dwordx4 v251, s[8:11], s68 offen lds
    s_lshl_b32 s68, s56, 7
    s_add_u32 s68, s68, s5
    s_add_u32 s68, s68, 1351680
    s_add_u32 m0, s66, 45056
    s_add_u32 s56, s56, 1
    s_cmp_eq_u32 s56, 10
    s_cselect_b32 s56, 0, s56
    buffer_load_dwordx4 v251, s[8:11], s68 offen lds
    s_lshl_b32 s68, s56, 7
    s_add_u32 s68, s68, s5
    s_add_u32 s68, s68, 1351680
    s_add_u32 m0, s66, 53248
    s_add_u32 s56, s56, 1
    s_cmp_eq_u32 s56, 10
    s_cselect_b32 s56, 0, s56
    buffer_load_dwordx4 v251, s[8:11], s68 offen lds
    s_lshl_b32 s68, s56, 7
    s_add_u32 s68, s68, s5
    s_add_u32 s68, s68, 1351680
    s_add_u32 m0, s66, 61440
    s_add_u32 s56, s56, 1
    s_cmp_eq_u32 s56, 10
    s_cselect_b32 s56, 0, s56
    buffer_load_dwordx4 v251, s[8:11], s68 offen lds
    s_lshl_b32 s68, s56, 7
    s_add_u32 s68, s68, s5
    s_add_u32 s68, s68, 1351680
    s_add_u32 m0, s66, 69632
    s_add_u32 s56, s56, 1
    s_cmp_eq_u32 s56, 10
    s_cselect_b32 s56, 0, s56
    buffer_load_dwordx4 v251, s[8:11], s68 offen lds
    s_lshl_b32 s68, s56, 7
    s_add_u32 s68, s68, s5
    s_add_u32 s68, s68, 1351680
    s_add_u32 m0, s66, 77824
    s_add_u32 s56, s56, 1
    s_cmp_eq_u32 s56, 10
    s_cselect_b32 s56, 0, s56
    buffer_load_dwordx4 v251, s[8:11], s68 offen lds
    s_lshl_b32 s68, s56, 7
    s_add_u32 s68, s68, s5
    s_add_u32 s68, s68, 1351680
    s_add_u32 m0, s66, 86016
    s_add_u32 s56, s56, 1
    s_cmp_eq_u32 s56, 10
    s_cselect_b32 s56, 0, s56
    buffer_load_dwordx4 v251, s[8:11], s68 offen lds
    s_lshl_b32 s68, s56, 7
    s_add_u32 s68, s68, s5
    s_add_u32 s68, s68, 1351680
    s_add_u32 m0, s66, 94208
    s_add_u32 s56, s56, 1
    s_cmp_eq_u32 s56, 10
    s_cselect_b32 s56, 0, s56
    buffer_load_dwordx4 v251, s[8:11], s68 offen lds
    s_lshl_b32 s68, s56, 7
    s_add_u32 s68, s68, s5
    s_add_u32 s68, s68, 1351680
    s_add_u32 m0, s66, 102400
    s_add_u32 s56, s56, 1
    s_cmp_eq_u32 s56, 10
    s_cselect_b32 s56, 0, s56
    buffer_load_dwordx4 v251, s[8:11], s68 offen lds
    s_waitcnt vmcnt(14)
    s_barrier
    v_lshrrev_b32 v1, 3, v255
    v_mul_u32_u24 v1, 3456, v1
    v_and_b32 v2, 7, v255
    v_lshl_add_u32 v1, v2, 7, v1
    s_lshl2_add_u32 s68, s45, s52
    s_mul_i32 s68, s68, 17280
    s_lshl_b32 s3, s44, 9
    s_sub_u32 s3, s3, 512
    s_lshl_b32 s69, s44, 8
    s_mov_b32 s70, 0x0f0f0f0f
    s_cmp_eq_u32 s44, 7
    s_cselect_b32 s70, 0x07070707, s70
    s_cmp_lt_u32 s44, 2
    s_cselect_b32 s3, s69, s3
    s_cselect_b32 s70, 0x03030303, s70
    s_add_u32 s68, s68, s3
    s_mov_b32 exec_lo, s70
    s_and_b32 exec_hi, s70, 0xff
    s_mov_b64 exec, -1
    v_lshrrev_b32 v1, 1, v255
    v_mul_u32_u24 v1, 1280, v1
    v_and_b32 v2, 1, v255
    v_lshl_add_u32 v1, v2, 7, v1
    s_mul_i32 s68, s45, 69120
    s_mul_i32 s3, s52, 17920
    s_add_u32 s68, s68, s3
    s_add_u32 s3, s44, 2
    s_lshl_b32 s69, s44, 1
    s_mov_b32 s70, 0x5555555
    s_cmp_lt_u32 s44, 2
    s_cselect_b32 s3, s69, s3
    s_cselect_b32 s70, 0xfffffff, s70
    s_lshl_b32 s3, s3, 7
    s_add_u32 s68, s68, s3
    s_mov_b32 exec_lo, s70
    s_mov_b32 exec_hi, 0
    buffer_load_dword v248, v1, s[32:35], s68 offen
    s_mov_b64 exec, -1
    s_waitcnt vmcnt(11)
    s_barrier
    s_setprio 0
    s_waitcnt vmcnt(1)
    s_barrier
    s_mul_i32 s68, s52, 10240
    s_add_u32 s68, s68, 32768
    s_add_u32 s3, s64, 122880
    s_add_u32 m0, s68, 0
    s_nop 0
    buffer_load_dwordx4 v180, s[16:19], s3 offen lds
    s_add_u32 m0, s68, 1024
    s_nop 0
    buffer_load_dwordx4 v181, s[16:19], s3 offen lds
    s_add_u32 m0, s68, 2048
    s_nop 0
    buffer_load_dwordx4 v182, s[16:19], s3 offen lds
    s_add_u32 m0, s68, 3072
    s_nop 0
    buffer_load_dwordx4 v183, s[16:19], s3 offen lds
    s_add_u32 m0, s68, 4096
    s_nop 0
    buffer_load_dwordx4 v184, s[16:19], s3 offen lds
    s_add_u32 s3, s64, 163840
    s_add_u32 m0, s68, 5120
    s_nop 0
    buffer_load_dwordx4 v180, s[16:19], s3 offen lds
    s_add_u32 m0, s68, 6144
    s_nop 0
    buffer_load_dwordx4 v181, s[16:19], s3 offen lds
    s_add_u32 m0, s68, 7168
    s_nop 0
    buffer_load_dwordx4 v182, s[16:19], s3 offen lds
    s_add_u32 m0, s68, 8192
    s_nop 0
    buffer_load_dwordx4 v183, s[16:19], s3 offen lds
    s_add_u32 m0, s68, 9216
    s_nop 0
    buffer_load_dwordx4 v184, s[16:19], s3 offen lds
    s_mul_i32 s3, s52, 11264
    s_add_u32 s3, s3, 41984
    v_subrev_u32 v249, s3, v190
    s_waitcnt vmcnt(0)
    ds_read_b64_tr_b16 v[160:161], v249 offset:0
    ds_read_b64_tr_b16 v[162:163], v249 offset:640
    ds_read_b64_tr_b16 v[164:165], v249 offset:32
    ds_read_b64_tr_b16 v[166:167], v249 offset:672
    ds_read_b64_tr_b16 v[168:169], v249 offset:64
    ds_read_b64_tr_b16 v[170:171], v249 offset:704
    ds_read_b64_tr_b16 v[172:173], v249 offset:96
    ds_read_b64_tr_b16 v[174:175], v249 offset:736
    ds_read_b64_tr_b16 v[176:177], v249 offset:128
    ds_read_b64_tr_b16 v[178:179], v249 offset:768
    s_waitcnt lgkmcnt(0)
    ds_read_b64_tr_b16 v[220:221], v249 offset:5120
    ds_read_b64_tr_b16 v[222:223], v249 offset:5760
    ds_read_b64_tr_b16 v[224:225], v249 offset:5152
    ds_read_b64_tr_b16 v[226:227], v249 offset:5792
    ds_read_b64_tr_b16 v[228:229], v249 offset:5184
    ds_read_b64_tr_b16 v[230:231], v249 offset:5824
    ds_read_b64_tr_b16 v[232:233], v249 offset:5216
    ds_read_b64_tr_b16 v[234:235], v249 offset:5856
    ds_read_b64_tr_b16 v[236:237], v249 offset:5248
    ds_read_b64_tr_b16 v[238:239], v249 offset:5888
    s_waitcnt lgkmcnt(0)
    v_mov_b32 v1, 160804
    v_mov_b32 v2, 1
    s_mov_b64 exec, 1
    ds_add_u32 v1, v2
    s_mov_b64 exec, -1
    v_mov_b32 v1, 160804
    s_mov_b32 s83, 0
Lspin_1:
    ds_read_b32 v2, v1
    s_add_u32 s83, s83, 1
    s_waitcnt lgkmcnt(0)
    v_readfirstlane_b32 s82, v2
    s_cmp_gt_u32 s83, 1600000
    s_cbranch_scc1 Lspd_2
    s_cmp_lt_u32 s82, 4
    s_cbranch_scc1 Lspin_1
Lspd_2:
    s_branch LY_afterA
LY_skipA:
    s_load_dword s6, s[40:41], 0
    s_load_dwordx2 s[32:33], s[0:1], 56
    s_load_dwordx2 s[36:37], s[0:1], 64
    s_load_dwordx2 s[16:17], s[0:1], 16
    s_load_dwordx2 s[20:21], s[0:1], 32
    s_load_dwordx2 s[24:25], s[0:1], 40
    s_load_dwordx2 s[28:29], s[0:1], 48
    s_mov_b32 s42, 268435456
    s_mov_b32 s43, 0x20000
    s_mov_b32 s18, 819200
    s_mov_b32 s19, 0x20000
    s_mov_b32 s22, 1280
    s_mov_b32 s23, 0x20000
    s_mov_b32 s26, 2211840
    s_mov_b32 s27, 0x20000
    s_mov_b32 s30, 2211840
    s_mov_b32 s31, 0x20000
    s_mov_b32 s34, 2211840
    s_mov_b32 s35, 0x20000
    s_mov_b32 s38, 2621440
    s_mov_b32 s39, 0x20000
    s_lshr_b32 s67, s45, 4
    s_and_b32 s3, s44, 1
    s_lshl1_add_u32 s67, s67, s3
    s_lshr_b32 s3, s44, 1
    s_lshl2_add_u32 s67, s67, s3
    s_and_b32 s3, s45, 15
    s_lshl4_add_u32 s67, s67, s3
    s_lshl2_add_u32 s67, s67, s52
    s_lshl_b32 s67, s67, 1
    v_lshrrev_b32 v1, 5, v255
    v_and_b32 v2, 31, v255
    v_mul_u32_u24 v7, 1280, v1
    v_lshl_add_u32 v8, v2, 3, v7
    v_lshl_add_u32 v7, v2, 4, v7
    s_mul_i32 s3, s67, 1280
    buffer_load_dwordx4 v[20:23], v7, s[8:11], s3 offen
    buffer_load_dwordx4 v[24:27], v7, s[8:11], s3 offen offset:512
    buffer_load_dwordx2 v[28:29], v8, s[8:11], s3 offen offset:1024
    s_and_b32 s3, s45, 3
    s_lshl2_add_u32 s48, s44, s3
    s_lshr_b32 s49, s45, 2
    s_lshl_b32 s51, s44, 4
    s_sub_u32 s51, s51, 16
    s_lshl_b32 s3, s44, 3
    s_lshl_b32 s60, s44, 2
    s_sub_u32 s60, s60, 8
    s_sub_u32 s61, s3, 8
    s_cmp_lt_u32 s44, 2
    s_cselect_b32 s51, s3, s51
    s_cselect_b32 s60, s61, s60
    s_cselect_b32 s3, 8, 16
    s_cselect_b32 s61, 16, 20
    s_cmp_lt_u32 s45, s61
    s_cselect_b32 s50, 1, 2
    s_cmp_lt_u32 s45, s3
    s_cselect_b32 s51, s51, s60
    s_cselect_b32 s50, 0, s50
    s_add_u32 s51, s51, s45
    s_cmp_ge_u32 s51, 108
    s_cselect_b32 s50, 2, s50
    s_mul_i32 s60, s49, 160
    s_xor_b32 s3, s53, 0
    s_lshl_b32 s3, s3, 5
    s_add_u32 s3, s3, s48
    s_lshl2_add_u32 s61, s3, s52
    s_mul_i32 s61, s61, 10240
    s_add_u32 s61, s61, s60
    s_lshl_b32 s62, s48, 13
    s_add_u32 s62, s62, 1048576
    s_mul_i32 s64, s52, 204800
    s_add_u32 s64, s64, s60
    s_mul_i32 s63, s52, 21504
    s_add_u32 s63, s63, 74752
    v_mov_b32 v1, v255
    v_mul_u32_u24 v2, 6554, v1
    v_lshrrev_b32 v2, 16, v2
    v_mul_u32_u24 v3, 10, v2
    v_sub_u32 v3, v1, v3
    v_mul_u32_u24 v2, 1280, v2
    v_lshl_add_u32 v180, v3, 4, v2
    v_add_u32 v1, 64, v1
    v_mul_u32_u24 v2, 6554, v1
    v_lshrrev_b32 v2, 16, v2
    v_mul_u32_u24 v3, 10, v2
    v_sub_u32 v3, v1, v3
    v_mul_u32_u24 v2, 1280, v2
    v_lshl_add_u32 v181, v3, 4, v2
    v_add_u32 v1, 64, v1
    v_mul_u32_u24 v2, 6554, v1
    v_lshrrev_b32 v2, 16, v2
    v_mul_u32_u24 v3, 10, v2
    v_sub_u32 v3, v1, v3
    v_mul_u32_u24 v2, 1280, v2
    v_lshl_add_u32 v182, v3, 4, v2
    v_add_u32 v1, 64, v1
    v_mul_u32_u24 v2, 6554, v1
    v_lshrrev_b32 v2, 16, v2
    v_mul_u32_u24 v3, 10, v2
    v_sub_u32 v3, v1, v3
    v_mul_u32_u24 v2, 1280, v2
    v_lshl_add_u32 v183, v3, 4, v2
    v_add_u32 v1, 64, v1
    v_mul_u32_u24 v2, 6554, v1
    v_lshrrev_b32 v2, 16, v2
    v_mul_u32_u24 v3, 10, v2
    v_sub_u32 v3, v1, v3
    v_mul_u32_u24 v2, 1280, v2
    v_lshl_add_u32 v184, v3, 4, v2
    v_lshrrev_b32 v1, 4, v255
    v_bfe_u32 v2, v255, 2, 2
    v_lshl_add_u32 v2, v1, 3, v2
    v_mul_u32_u24 v2, 160, v2
    v_and_b32 v3, 3, v255
    v_lshl_add_u32 v2, v3, 3, v2
    v_add_u32 v190, s63, v2
    v_and_b32 v3, 15, v255
    v_mul_u32_u24 v2, 32768, v1
    v_lshl_add_u32 v191, v3, 4, v2
    v_lshl_add_u32 v192, v3, 3, v2
    v_and_b32 v193, 7, v255
    v_min_u32 v193, 4, v193
    v_lshlrev_b32 v193, 7, v193
    v_and_b32 v2, 8, v255
    v_lshl_add_u32 v193, v2, 14, v193
    v_bfe_u32 v192, v255, 1, 2
    v_mul_u32_u24 v192, 163840, v192
    v_lshl_add_u32 v192, v2, 11, v192
    v_and_b32 v2, 1, v255
    v_lshl_add_u32 v192, v2, 3, v192
    v_mul_u32_u24 v3, 336, v3
    v_lshl_add_u32 v3, v1, 4, v3
    v_add_u32 v194, s63, v3
    v_lshlrev_b32 v252, 4, v255
    s_waitcnt lgkmcnt(0) vmcnt(0)
    s_mul_i32 s6, s6, 1664525
    s_add_u32 s6, s6, 1013904223
    s_bitset0_b32 s6, 31
    v_lshlrev_b32 v120, 16, v20
    v_and_b32 v121, 0xffff0000, v20
    v_lshlrev_b32 v122, 16, v21
    v_and_b32 v123, 0xffff0000, v21
    v_lshlrev_b32 v124, 16, v22
    v_and_b32 v125, 0xffff0000, v22
    v_lshlrev_b32 v126, 16, v23
    v_and_b32 v127, 0xffff0000, v23
    v_lshlrev_b32 v128, 16, v24
    v_and_b32 v129, 0xffff0000, v24
    v_lshlrev_b32 v130, 16, v25
    v_and_b32 v131, 0xffff0000, v25
    v_lshlrev_b32 v132, 16, v26
    v_and_b32 v133, 0xffff0000, v26
    v_lshlrev_b32 v134, 16, v27
    v_and_b32 v135, 0xffff0000, v27
    v_lshlrev_b32 v136, 16, v28
    v_and_b32 v137, 0xffff0000, v28
    v_lshlrev_b32 v138, 16, v29
    v_and_b32 v139, 0xffff0000, v29
    v_add_f32 v10, v120, v121
    v_add_f32 v11, v122, v123
    v_add_f32 v10, v10, v124
    v_add_f32 v11, v11, v125
    v_add_f32 v10, v10, v126
    v_add_f32 v11, v11, v127
    v_add_f32 v10, v10, v128
    v_add_f32 v11, v11, v129
    v_add_f32 v10, v10, v130
    v_add_f32 v11, v11, v131
    v_add_f32 v10, v10, v132
    v_add_f32 v11, v11, v133
    v_add_f32 v10, v10, v134
    v_add_f32 v11, v11, v135
    v_add_f32 v10, v10, v136
    v_add_f32 v11, v11, v137
    v_add_f32 v10, v10, v138
    v_add_f32 v11, v11, v139
    v_add_f32 v10, v10, v11
    s_nop 1
    v_add_f32_dpp v10, v10, v10 quad_perm:[1,0,3,2] row_mask:0xf bank_mask:0xf
    s_nop 1
    v_add_f32_dpp v10, v10, v10 quad_perm:[2,3,0,1] row_mask:0xf bank_mask:0xf
    s_nop 1
    v_add_f32_dpp v10, v10, v10 row_half_mirror row_mask:0xf bank_mask:0xf
    s_nop 1
    v_add_f32_dpp v10, v10, v10 row_mirror row_mask:0xf bank_mask:0xf
    v_mov_b32 v11, v10
    s_nop 1
    v_permlane16_swap_b32 v10, v11
    v_add_f32 v10, v10, v11
    v_mul_f32 v10, 0x3acccccd, v10
    v_sub_f32 v120, v120, v10
    v_sub_f32 v121, v121, v10
    v_sub_f32 v122, v122, v10
    v_sub_f32 v123, v123, v10
    v_sub_f32 v124, v124, v10
    v_sub_f32 v125, v125, v10
    v_sub_f32 v126, v126, v10
    v_sub_f32 v127, v127, v10
    v_sub_f32 v128, v128, v10
    v_sub_f32 v129, v129, v10
    v_sub_f32 v130, v130, v10
    v_sub_f32 v131, v131, v10
    v_sub_f32 v132, v132, v10
    v_sub_f32 v133, v133, v10
    v_sub_f32 v134, v134, v10
    v_sub_f32 v135, v135, v10
    v_sub_f32 v136, v136, v10
    v_sub_f32 v137, v137, v10
    v_sub_f32 v138, v138, v10
    v_sub_f32 v139, v139, v10
    v_mul_f32 v11, v120, v120
    v_mul_f32 v12, v121, v121
    v_fmac_f32 v11, v122, v122
    v_fmac_f32 v12, v123, v123
    v_fmac_f32 v11, v124, v124
    v_fmac_f32 v12, v125, v125
    v_fmac_f32 v11, v126, v126
    v_fmac_f32 v12, v127, v127
    v_fmac_f32 v11, v128, v128
    v_fmac_f32 v12, v129, v129
    v_fmac_f32 v11, v130, v130
    v_fmac_f32 v12, v131, v131
    v_fmac_f32 v11, v132, v132
    v_fmac_f32 v12, v133, v133
    v_fmac_f32 v11, v134, v134
    v_fmac_f32 v12, v135, v135
    v_fmac_f32 v11, v136, v136
    v_fmac_f32 v12, v137, v137
    v_fmac_f32 v11, v138, v138
    v_fmac_f32 v12, v139, v139
    v_add_f32 v11, v11, v12
    s_nop 1
    v_add_f32_dpp v11, v11, v11 quad_perm:[1,0,3,2] row_mask:0xf bank_mask:0xf
    s_nop 1
    v_add_f32_dpp v11, v11, v11 quad_perm:[2,3,0,1] row_mask:0xf bank_mask:0xf
    s_nop 1
    v_add_f32_dpp v11, v11, v11 row_half_mirror row_mask:0xf bank_mask:0xf
    s_nop 1
    v_add_f32_dpp v11, v11, v11 row_mirror row_mask:0xf bank_mask:0xf
    v_mov_b32 v12, v11
    s_nop 1
    v_permlane16_swap_b32 v11, v12
    v_add_f32 v11, v11, v12
    v_mul_f32 v11, 0x3acccccd, v11
    v_cvt_pk_bf16_f32 v11, v11, v11
    v_lshlrev_b32 v11, 16, v11
    v_add_f32 v11, 0x3727c5ac, v11
    v_cvt_pk_bf16_f32 v11, v11, v11
    v_lshlrev_b32 v11, 16, v11
    v_sqrt_f32 v11, v11
    v_cvt_pk_bf16_f32 v13, v10, v10
    v_lshlrev_b32 v13, 16, v13
    v_cvt_pk_bf16_f32 v11, v11, v11
    v_lshlrev_b32 v11, 16, v11
    v_rcp_f32 v12, v11
    v_mov_b32 v14, s6
    v_mov_b32 v15, s6
    v_lshrrev_b32 v9, 1, v255
    s_lshl_b32 s3, s67, 4
    s_add_u32 s3, s3, 688128
    s_mov_b32 exec_lo, 0x1
    s_mov_b32 exec_hi, 0x1
    buffer_store_dwordx4 v[12:15], v9, s[40:43], s3 offen sc1
    s_mov_b64 exec, -1
    s_barrier
    v_lshrrev_b32 v1, 3, v255
    v_mul_u32_u24 v1, 3456, v1
    v_and_b32 v2, 7, v255
    v_lshl_add_u32 v1, v2, 7, v1
    s_lshl2_add_u32 s68, s45, s52
    s_mul_i32 s68, s68, 17280
    s_lshl_b32 s3, s44, 9
    s_sub_u32 s3, s3, 512
    s_lshl_b32 s69, s44, 8
    s_mov_b32 s70, 0x0f0f0f0f
    s_cmp_eq_u32 s44, 7
    s_cselect_b32 s70, 0x07070707, s70
    s_cmp_lt_u32 s44, 2
    s_cselect_b32 s3, s69, s3
    s_cselect_b32 s70, 0x03030303, s70
    s_add_u32 s68, s68, s3
    s_mov_b32 exec_lo, s70
    s_and_b32 exec_hi, s70, 0xff
    s_mov_b64 exec, -1
    v_lshrrev_b32 v1, 1, v255
    v_mul_u32_u24 v1, 1280, v1
    v_and_b32 v2, 1, v255
    v_lshl_add_u32 v1, v2, 7, v1
    s_mul_i32 s68, s45, 69120
    s_mul_i32 s3, s52, 17920
    s_add_u32 s68, s68, s3
    s_add_u32 s3, s44, 2
    s_lshl_b32 s69, s44, 1
    s_mov_b32 s70, 0x5555555
    s_cmp_lt_u32 s44, 2
    s_cselect_b32 s3, s69, s3
    s_cselect_b32 s70, 0xfffffff, s70
    s_lshl_b32 s3, s3, 7
    s_add_u32 s68, s68, s3
    s_mov_b32 exec_lo, s70
    s_mov_b32 exec_hi, 0
    buffer_load_dword v248, v1, s[32:35], s68 offen
    s_mov_b64 exec, -1
    s_add_u32 s68, s49, 0
    s_and_b32 s73, s48, 1
    s_lshr_b32 s69, s48, 1
    s_mul_i32 s69, s69, 5
    s_add_u32 s71, s69, 2
    s_mul_i32 s3, s73, 3
    s_add_u32 s70, s69, s3
    s_lshl1_add_u32 s69, s73, s69
    s_lshl_b32 s72, s68, 1
    s_sub_u32 s72, s72, 4
    s_lshl2_add_u32 s55, s68, s52
    s_lshl_b32 s3, s55, 9
    s_add_u32 s3, s3, 16777216
    s_mul_i32 s57, s70, 32768
    s_add_u32 s57, s57, s3
    s_mul_i32 s58, s71, 32768
    s_add_u32 s58, s58, s3
    s_lshl3_add_u32 s58, s73, s58
    s_add_u32 s55, s55, 1
    s_mov_b32 s54, 0
    s_lshr_b32 s3, s52, 1
    s_add_u32 s3, s3, 4
    s_sub_u32 s3, s3, s52
    v_bfe_u32 v1, v255, 2, 1
    v_mul_u32_u24 v1, s3, v1
    s_add_u32 s3, s72, s52
    v_add_u32 v1, s3, v1
    v_max_i32 v1, 0, v1
    s_and_b32 s3, s52, 1
    s_lshl_b32 s3, s3, 4
    s_add_u32 s3, s3, 0x19
    v_and_b32 v2, 6, v255
    v_lshrrev_b32 v3, v2, s3
    v_and_b32 v3, 3, v3
    v_mul_u32_u24 v3, 80, v3
    v_and_b32 v2, 1, v255
    v_lshl_add_u32 v3, v2, 1, v3
    v_add_u32 v3, s69, v3
    v_lshrrev_b32 v3, 2, v3
    v_lshl_add_u32 v1, v1, 6, v3
    v_lshlrev_b32 v157, 7, v1
    v_lshrrev_b32 v1, 5, v255
    v_and_b32 v2, 31, v255
    s_lshl_b32 s3, s52, 9
    s_add_u32 s3, s3, 0
    v_lshl_add_u32 v153, v2, 4, s3
    v_mul_u32_u24 v3, 6208, v1
    v_add_u32 v152, v153, v3
    v_add_u32 v153, 12416, v153
    v_lshl_add_u32 v153, s73, 3, v153
    v_lshlrev_b32 v3, 2, v1
    v_sub_u32 v7, v2, v3
    v_bfe_u32 v4, v255, 2, 2
    v_add_u32 v3, v3, v4
    v_lshlrev_b32 v3, 4, v3
    v_and_b32 v4, 1, v255
    v_mul_u32_u24 v4, 6208, v4
    v_bfe_u32 v5, v255, 1, 1
    v_lshl_add_u32 v4, v5, 3, v4
    s_lshl_b32 s74, s73, 3
    s_add_u32 s74, s74, 12416
    v_mov_b32 v5, s74
    v_and_b32 v6, 16, v255
    v_cmp_ne_u32 vcc, 0, v6
    s_nop 1
    v_cndmask_b32 v4, v4, v5, vcc
    s_add_u32 s3, s3, 22720
    v_add3_u32 v4, v4, v3, s3
    v_add_u32 v5, 161920, v3
    v_and_b32 v6, 19, v255
    v_cmp_lt_u32 vcc, 16, v6
    s_nop 1
    v_cndmask_b32 v156, v4, v5, vcc
    v_mov_b32 v4, 512
    v_cndmask_b32 v155, v4, 0, vcc
    v_lshlrev_b32 v104, 4, v2
    v_mul_u32_u24 v158, 32768, v1
    v_add_u32 v158, v158, v104
    v_lshlrev_b32 v159, 4, v2
    v_lshlrev_b32 v105, 4, v255
    v_mov_b32 v4, 0xff800000
    s_cmp_lt_u32 s55, 9
    s_cselect_b32 s3, 0, -1
    v_mov_b32 v5, 0xffff
    v_subrev_u32 v64, 0, v7
    v_ashrrev_i32 v64, 31, v64
    v_mov_b32 v48, 0
    v_subrev_u32 v65, 1, v7
    v_ashrrev_i32 v65, 31, v65
    v_mov_b32 v49, 0
    v_subrev_u32 v66, 2, v7
    v_ashrrev_i32 v66, 31, v66
    v_mov_b32 v50, 0
    v_subrev_u32 v67, 3, v7
    v_ashrrev_i32 v67, 31, v67
    v_mov_b32 v51, 0
    v_subrev_u32 v68, 8, v7
    v_ashrrev_i32 v68, 31, v68
    v_mov_b32 v52, 0
    v_subrev_u32 v69, 9, v7
    v_ashrrev_i32 v69, 31, v69
    v_mov_b32 v53, 0
    v_subrev_u32 v70, 10, v7
    v_ashrrev_i32 v70, 31, v70
    v_mov_b32 v54, 0
    v_subrev_u32 v71, 11, v7
    v_ashrrev_i32 v71, 31, v71
    v_mov_b32 v55, 0
    v_subrev_u32 v72, 16, v7
    v_ashrrev_i32 v72, 31, v72
    v_mov_b32 v56, 0
    v_subrev_u32 v73, 17, v7
    v_ashrrev_i32 v73, 31, v73
    v_mov_b32 v57, 0
    v_subrev_u32 v74, 18, v7
    v_ashrrev_i32 v74, 31, v74
    v_mov_b32 v58, 0
    v_subrev_u32 v75, 19, v7
    v_ashrrev_i32 v75, 31, v75
    v_mov_b32 v59, 0
    v_subrev_u32 v76, 24, v7
    v_ashrrev_i32 v76, 31, v76
    v_mov_b32 v60, 0
    v_subrev_u32 v77, 25, v7
    v_ashrrev_i32 v77, 31, v77
    v_mov_b32 v61, 0
    v_subrev_u32 v78, 26, v7
    v_ashrrev_i32 v78, 31, v78
    v_mov_b32 v62, 0
    v_subrev_u32 v79, 27, v7
    v_ashrrev_i32 v79, 31, v79
    v_mov_b32 v63, 0
    v_bitop3_b32 v88, v5, v64, v65 bitop3:0xca
    v_not_b32 v80, v88
    v_and_b32 v88, s3, v88
    v_bitop3_b32 v89, v5, v66, v67 bitop3:0xca
    v_not_b32 v81, v89
    v_and_b32 v89, s3, v89
    v_bitop3_b32 v90, v5, v68, v69 bitop3:0xca
    v_not_b32 v82, v90
    v_and_b32 v90, s3, v90
    v_bitop3_b32 v91, v5, v70, v71 bitop3:0xca
    v_not_b32 v83, v91
    v_and_b32 v91, s3, v91
    v_bitop3_b32 v92, v5, v72, v73 bitop3:0xca
    v_not_b32 v84, v92
    v_and_b32 v92, s3, v92
    v_bitop3_b32 v93, v5, v74, v75 bitop3:0xca
    v_not_b32 v85, v93
    v_and_b32 v93, s3, v93
    v_bitop3_b32 v94, v5, v76, v77 bitop3:0xca
    v_not_b32 v86, v94
    v_and_b32 v94, s3, v94
    v_bitop3_b32 v95, v5, v78, v79 bitop3:0xca
    v_not_b32 v87, v95
    v_and_b32 v95, s3, v95
    s_mul_i32 s68, s52, 10240
    s_add_u32 s68, s68, 32768
    s_add_u32 s3, s64, 122880
    s_add_u32 m0, s68, 0
    s_nop 0
    buffer_load_dwordx4 v180, s[16:19], s3 offen lds
    s_add_u32 m0, s68, 1024
    s_nop 0
    buffer_load_dwordx4 v181, s[16:19], s3 offen lds
    s_add_u32 m0, s68, 2048
    s_nop 0
    buffer_load_dwordx4 v182, s[16:19], s3 offen lds
    s_add_u32 m0, s68, 3072
    s_nop 0
    buffer_load_dwordx4 v183, s[16:19], s3 offen lds
    s_add_u32 m0, s68, 4096
    s_nop 0
    buffer_load_dwordx4 v184, s[16:19], s3 offen lds
    s_add_u32 s3, s64, 163840
    s_add_u32 m0, s68, 5120
    s_nop 0
    buffer_load_dwordx4 v180, s[16:19], s3 offen lds
    s_add_u32 m0, s68, 6144
    s_nop 0
    buffer_load_dwordx4 v181, s[16:19], s3 offen lds
    s_add_u32 m0, s68, 7168
    s_nop 0
    buffer_load_dwordx4 v182, s[16:19], s3 offen lds
    s_add_u32 m0, s68, 8192
    s_nop 0
    buffer_load_dwordx4 v183, s[16:19], s3 offen lds
    s_add_u32 m0, s68, 9216
    s_nop 0
    buffer_load_dwordx4 v184, s[16:19], s3 offen lds
    s_mul_i32 s3, s52, 11264
    s_add_u32 s3, s3, 41984
    v_subrev_u32 v249, s3, v190
    s_waitcnt vmcnt(0)
    ds_read_b64_tr_b16 v[160:161], v249 offset:0
    ds_read_b64_tr_b16 v[162:163], v249 offset:640
    ds_read_b64_tr_b16 v[164:165], v249 offset:32
    ds_read_b64_tr_b16 v[166:167], v249 offset:672
    ds_read_b64_tr_b16 v[168:169], v249 offset:64
    ds_read_b64_tr_b16 v[170:171], v249 offset:704
    ds_read_b64_tr_b16 v[172:173], v249 offset:96
    ds_read_b64_tr_b16 v[174:175], v249 offset:736
    ds_read_b64_tr_b16 v[176:177], v249 offset:128
    ds_read_b64_tr_b16 v[178:179], v249 offset:768
    s_waitcnt lgkmcnt(0)
    ds_read_b64_tr_b16 v[220:221], v249 offset:5120
    ds_read_b64_tr_b16 v[222:223], v249 offset:5760
    ds_read_b64_tr_b16 v[224:225], v249 offset:5152
    ds_read_b64_tr_b16 v[226:227], v249 offset:5792
    ds_read_b64_tr_b16 v[228:229], v249 offset:5184
    ds_read_b64_tr_b16 v[230:231], v249 offset:5824
    ds_read_b64_tr_b16 v[232:233], v249 offset:5216
    ds_read_b64_tr_b16 v[234:235], v249 offset:5856
    ds_read_b64_tr_b16 v[236:237], v249 offset:5248
    ds_read_b64_tr_b16 v[238:239], v249 offset:5888
    s_waitcnt lgkmcnt(0)
    v_mov_b32 v1, 160804
    v_mov_b32 v2, 1
    s_mov_b64 exec, 1
    ds_add_u32 v1, v2
    s_mov_b64 exec, -1
    v_mov_b32 v1, 160804
    s_mov_b32 s83, 0
Lspin_3:
    ds_read_b32 v2, v1
    s_add_u32 s83, s83, 1
    s_waitcnt lgkmcnt(0)
    v_readfirstlane_b32 s82, v2
    s_cmp_gt_u32 s83, 1600000
    s_cbranch_scc1 Lspd_4
    s_cmp_lt_u32 s82, 4
    s_cbranch_scc1 Lspin_3
Lspd_4:
LY_afterA:
    s_setprio 0
    s_mul_i32 s65, s52, 655360
    s_lshl_b32 s3, s48, 9
    s_add_u32 s65, s65, s3
    s_add_u32 s65, s65, 16777216
    s_lshr_b32 s66, s48, 1
    s_lshl_b32 s66, s66, 6
    s_mul_i32 s3, s52, 5
    s_add_u32 s66, s66, s3
    s_lshl_b32 s66, s66, 7
    s_add_u32 s66, s66, 65536
    s_add_u32 s68, s49, 0
    s_and_b32 s73, s48, 1
    s_lshr_b32 s69, s48, 1
    s_mul_i32 s69, s69, 5
    s_add_u32 s71, s69, 2
    s_mul_i32 s3, s73, 3
    s_add_u32 s70, s69, s3
    s_lshl1_add_u32 s69, s73, s69
    s_lshl_b32 s72, s68, 1
    s_sub_u32 s72, s72, 4
    s_add_u32 s74, s72, s52
    s_max_i32 s74, s74, 0
    s_lshl_b32 s74, s74, 10
    s_lshl_b32 s77, s52, 10
    s_add_u32 s77, s77, 0
    s_lshl2_add_u32 s75, s68, s52
    s_lshl_b32 s75, s75, 9
    s_add_u32 s75, s75, 16777216
    s_lshr_b32 s3, s52, 1
    s_add_u32 s78, s72, s3
    s_add_u32 s78, s78, 4
    s_lshl_b32 s78, s78, 10
    s_lshl_b32 s79, s3, 10
    s_add_u32 s79, s79, 4096
    s_bitcmp1_b32 s52, 0
    s_cselect_b32 s3, 2621440, 0
    s_cselect_b32 s76, 18624, 0
    s_add_u32 s78, s78, s3
    s_add_u32 s79, s79, s76
    s_mul_i32 s70, s70, 32768
    s_mul_i32 s71, s71, 32768
    s_add_u32 s74, s74, 19398656
    s_add_u32 s78, s78, 19398656
    s_mov_b32 s80, 65536
    s_mov_b64 exec, 0xff
    s_mov_b32 s83, 0
Lpoll_5:
    buffer_load_dword v96, v157, s[40:43], s80 offen sc1
    s_add_u32 s83, s83, 1
    s_waitcnt vmcnt(0)
    v_cmp_ne_u32 vcc, s6, v96
    s_cbranch_vccz Lpd_6
    s_cmp_lt_u32 s83, 200000
    s_cbranch_scc1 Lpoll_5
Lpd_6:
    s_mov_b64 exec, -1
    s_add_u32 s3, s70, s78
    s_add_u32 m0, s79, 0
    s_add_u32 s76, s70, s75
    buffer_load_dwordx4 v105, s[40:43], s3 offen sc1 lds
    buffer_load_dwordx4 v[144:147], v158, s[40:43], s76 offen sc1
    s_add_u32 s3, s70, s78
    s_add_u32 s3, s3, 32768
    s_add_u32 m0, s79, 6208
    s_add_u32 s76, s70, s75
    buffer_load_dwordx4 v105, s[40:43], s3 offen sc1 lds
    s_add_u32 s3, s71, s78
    s_add_u32 m0, s79, 12416
    s_add_u32 s76, s71, s75
    buffer_load_dwordx4 v105, s[40:43], s3 offen sc1 lds
    buffer_load_dwordx4 v[148:151], v104, s[40:43], s76 offen sc1
    s_add_u32 s76, s70, s74
    s_add_u32 m0, s77, 0
    s_add_u32 s3, s76, 2621440
    buffer_load_dwordx4 v105, s[40:43], s76 offen sc1 lds
    s_add_u32 m0, s77, 18624
    s_nop 0
    buffer_load_dwordx4 v105, s[40:43], s3 offen sc1 lds
    s_add_u32 s76, s70, s74
    s_add_u32 s76, s76, 32768
    s_add_u32 m0, s77, 6208
    s_add_u32 s3, s76, 2621440
    buffer_load_dwordx4 v105, s[40:43], s76 offen sc1 lds
    s_add_u32 m0, s77, 24832
    s_nop 0
    buffer_load_dwordx4 v105, s[40:43], s3 offen sc1 lds
    s_add_u32 s76, s71, s74
    s_add_u32 m0, s77, 12416
    s_add_u32 s3, s76, 2621440
    buffer_load_dwordx4 v105, s[40:43], s76 offen sc1 lds
    s_add_u32 m0, s77, 31040
    s_nop 0
    buffer_load_dwordx4 v105, s[40:43], s3 offen sc1 lds
    v_mov_b32 v1, 160788
    v_mov_b32 v2, 1
    s_mov_b64 exec, 1
    ds_add_u32 v1, v2
    s_mov_b64 exec, -1
    v_mov_b32 v1, 160768
    s_mov_b32 s83, 0
Lspin_7:
    ds_read_b32 v2, v1
    s_add_u32 s83, s83, 1
    s_waitcnt lgkmcnt(0)
    v_readfirstlane_b32 s82, v2
    s_cmp_gt_u32 s83, 1600000
    s_cbranch_scc1 Lspd_8
    s_cmp_lt_u32 s82, 4
    s_cbranch_scc1 Lspin_7
Lspd_8:
    s_setprio 2
    v_mov_b32 v1, 160772
    v_mov_b32 v2, 1
    s_waitcnt vmcnt(0)
    s_mov_b64 exec, 1
    ds_add_u32 v1, v2
    s_bitcmp1_b32 s48, 0
    s_cselect_b32 exec_lo, -1, 0
    s_mov_b32 exec_hi, 0
    v_mov_b32 v148, v150
    v_mov_b32 v149, v151
    s_mov_b32 exec_lo, 0x0
    s_mov_b32 exec_hi, 0xffffffff
    v_mov_b32 v148, 0
    v_mov_b32 v149, 0
    s_mov_b64 exec, -1
    v_mov_b32 v150, 0
    v_mov_b32 v151, 0
    v_mov_b32 v118, 0
    v_mov_b32 v119, 0
    v_mov_b32 v126, 0
    v_mov_b32 v127, 0
    v_mov_b32 v1, 160772
    s_mov_b32 s83, 0
Lspin_9:
    ds_read_b32 v2, v1
    s_add_u32 s83, s83, 1
    s_waitcnt lgkmcnt(0)
    v_readfirstlane_b32 s82, v2
    s_cmp_gt_u32 s83, 1600000
    s_cbranch_scc1 Lspd_10
    s_cmp_lt_u32 s82, 4
    s_cbranch_scc1 Lspin_9
Lspd_10:
LB_main1:
    ds_read_b128 v[112:115], v152 offset:4096
    ds_read_b64 v[116:117], v153 offset:4096
    ds_read_b128 v[120:123], v152
    ds_read_b64 v[124:125], v153
    v_lshlrev_b32 v154, 3, v155
    v_sub_u32 v154, v156, v154
    ds_read_b64_tr_b16 v[136:137], v154 offset:0
    ds_read_b64_tr_b16 v[138:139], v154 offset:128
    ds_read_b64_tr_b16 v[140:141], v154 offset:256
    ds_read_b64_tr_b16 v[142:143], v154 offset:384
    ds_read_b64_tr_b16 v[128:129], v156 offset:0
    ds_read_b64_tr_b16 v[130:131], v156 offset:128
    ds_read_b64_tr_b16 v[132:133], v156 offset:256
    ds_read_b64_tr_b16 v[134:135], v156 offset:384
    v_sub_u32 v154, v156, v155
    s_waitcnt lgkmcnt(10)
    v_mfma_f32_32x32x16_bf16 v[0:15], v[112:115], v[144:147], v[48:63]
    v_mfma_f32_32x32x16_bf16 v[0:15], v[116:119], v[148:151], v[0:15]
    s_waitcnt lgkmcnt(8)
    v_mfma_f32_32x32x16_bf16 v[16:31], v[120:123], v[144:147], v[48:63]
    v_mfma_f32_32x32x16_bf16 v[16:31], v[124:127], v[148:151], v[16:31]
    ds_read_b128 v[112:115], v152 offset:3072
    ds_read_b64 v[116:117], v153 offset:3072
    ds_read_b128 v[120:123], v152 offset:3584
    ds_read_b64 v[124:125], v153 offset:3584
    s_add_u32 m0, s63, 0
    s_add_u32 s3, s64, 0
    buffer_load_dwordx4 v180, s[16:19], s3 offen lds
    s_cmp_eq_u32 s55, 1
    s_cbranch_scc1 Linv_11
Linvb_12:
    s_nop 2
    v_bitop3_b32 v0, v64, v16, v0 bitop3:0xca
    v_bitop3_b32 v1, v65, v17, v1 bitop3:0xca
    v_bitop3_b32 v2, v66, v18, v2 bitop3:0xca
    v_bitop3_b32 v3, v67, v19, v3 bitop3:0xca
    v_bitop3_b32 v4, v68, v20, v4 bitop3:0xca
    v_bitop3_b32 v5, v69, v21, v5 bitop3:0xca
    v_bitop3_b32 v6, v70, v22, v6 bitop3:0xca
    v_bitop3_b32 v7, v71, v23, v7 bitop3:0xca
    v_bitop3_b32 v8, v72, v24, v8 bitop3:0xca
    v_bitop3_b32 v9, v73, v25, v9 bitop3:0xca
    v_bitop3_b32 v10, v74, v26, v10 bitop3:0xca
    v_bitop3_b32 v11, v75, v27, v11 bitop3:0xca
    v_bitop3_b32 v12, v76, v28, v12 bitop3:0xca
    v_bitop3_b32 v13, v77, v29, v13 bitop3:0xca
    v_bitop3_b32 v14, v78, v30, v14 bitop3:0xca
    v_bitop3_b32 v15, v79, v31, v15 bitop3:0xca
    s_waitcnt lgkmcnt(0)
    v_exp_f32 v0, v0
    v_exp_f32 v1, v1
    v_exp_f32 v2, v2
    v_exp_f32 v3, v3
    v_mfma_f32_32x32x16_bf16 v[16:31], v[120:123], v[144:147], v[48:63]
    v_exp_f32 v4, v4
    v_exp_f32 v5, v5
    v_exp_f32 v6, v6
    v_exp_f32 v7, v7
    v_mfma_f32_32x32x16_bf16 v[16:31], v[124:127], v[148:151], v[16:31]
    v_cvt_pk_bf16_f32 v96, v0, v1
    v_cvt_pk_bf16_f32 v97, v2, v3
    v_cvt_pk_bf16_f32 v98, v4, v5
    v_cvt_pk_bf16_f32 v99, v6, v7
    v_and_b32 v104, v96, v88
    v_and_b32 v96, v96, v80
    v_and_b32 v105, v97, v89
    v_and_b32 v97, v97, v81
    v_and_b32 v106, v98, v90
    v_and_b32 v98, v98, v82
    v_and_b32 v107, v99, v91
    v_and_b32 v99, v99, v83
    v_exp_f32 v8, v8
    v_exp_f32 v9, v9
    v_exp_f32 v10, v10
    v_exp_f32 v11, v11
    v_mfma_f32_32x32x16_bf16 v[32:47], v[128:131], v[96:99], 0
    s_add_u32 m0, s63, 1024
    s_add_u32 s3, s64, 0
    buffer_load_dwordx4 v181, s[16:19], s3 offen lds
    v_exp_f32 v12, v12
    v_exp_f32 v13, v13
    v_exp_f32 v14, v14
    v_exp_f32 v15, v15
    v_mfma_f32_32x32x16_bf16 v[32:47], v[136:139], v[104:107], v[32:47]
    v_cvt_pk_bf16_f32 v100, v8, v9
    v_cvt_pk_bf16_f32 v101, v10, v11
    v_cvt_pk_bf16_f32 v102, v12, v13
    v_cvt_pk_bf16_f32 v103, v14, v15
    v_and_b32 v108, v100, v92
    v_and_b32 v100, v100, v84
    v_and_b32 v109, v101, v93
    v_and_b32 v101, v101, v85
    v_and_b32 v110, v102, v94
    v_and_b32 v102, v102, v86
    v_and_b32 v111, v103, v95
    v_and_b32 v103, v103, v87
    s_nop 0
    v_mfma_f32_32x32x16_bf16 v[32:47], v[140:143], v[108:111], v[32:47]
    ds_read_b64_tr_b16 v[136:137], v154 offset:0
    ds_read_b64_tr_b16 v[138:139], v154 offset:128
    ds_read_b64_tr_b16 v[140:141], v154 offset:256
    ds_read_b64_tr_b16 v[142:143], v154 offset:384
    v_sub_u32 v154, v154, v155
    v_mfma_f32_32x32x16_bf16 v[32:47], v[132:135], v[100:103], v[32:47]
    s_cmp_eq_u32 s55, 2
    s_cbranch_scc1 Linv_13
Linvb_14:
    s_add_u32 m0, s63, 2048
    s_add_u32 s3, s64, 0
    buffer_load_dwordx4 v182, s[16:19], s3 offen lds
    s_waitcnt lgkmcnt(4)
    v_exp_f32 v16, v16
    v_exp_f32 v17, v17
    v_exp_f32 v18, v18
    v_exp_f32 v19, v19
    v_mfma_f32_32x32x16_bf16 v[0:15], v[112:115], v[144:147], v[48:63]
    ds_read_b128 v[120:123], v152 offset:2560
    ds_read_b64 v[124:125], v153 offset:2560
    v_exp_f32 v20, v20
    v_exp_f32 v21, v21
    v_exp_f32 v22, v22
    v_exp_f32 v23, v23
    v_mfma_f32_32x32x16_bf16 v[0:15], v[116:119], v[148:151], v[0:15]
    ds_read_b64_tr_b16 v[128:129], v154 offset:0
    ds_read_b64_tr_b16 v[130:131], v154 offset:128
    s_waitcnt lgkmcnt(4)
    v_cvt_pk_bf16_f32 v96, v16, v17
    v_cvt_pk_bf16_f32 v97, v18, v19
    v_cvt_pk_bf16_f32 v98, v20, v21
    v_cvt_pk_bf16_f32 v99, v22, v23
    v_exp_f32 v24, v24
    v_exp_f32 v25, v25
    v_exp_f32 v26, v26
    v_exp_f32 v27, v27
    v_mfma_f32_32x32x16_bf16 v[32:47], v[136:139], v[96:99], v[32:47]
    ds_read_b64_tr_b16 v[132:133], v154 offset:256
    ds_read_b64_tr_b16 v[134:135], v154 offset:384
    s_add_u32 m0, s63, 3072
    s_add_u32 s3, s64, 0
    buffer_load_dwordx4 v183, s[16:19], s3 offen lds
    v_exp_f32 v28, v28
    v_exp_f32 v29, v29
    v_exp_f32 v30, v30
    v_exp_f32 v31, v31
    v_cvt_pk_bf16_f32 v100, v24, v25
    v_cvt_pk_bf16_f32 v101, v26, v27
    v_cvt_pk_bf16_f32 v102, v28, v29
    v_cvt_pk_bf16_f32 v103, v30, v31
    v_sub_u32 v154, v154, v155
    s_nop 0
    v_mfma_f32_32x32x16_bf16 v[32:47], v[140:143], v[100:103], v[32:47]
    s_cmp_eq_u32 s55, 3
    s_cbranch_scc1 Linv_15
Linvb_16:
    s_add_u32 m0, s63, 4096
    s_add_u32 s3, s64, 0
    buffer_load_dwordx4 v184, s[16:19], s3 offen lds
    s_waitcnt lgkmcnt(0)
    v_exp_f32 v0, v0
    v_exp_f32 v1, v1
    v_exp_f32 v2, v2
    v_exp_f32 v3, v3
    v_mfma_f32_32x32x16_bf16 v[16:31], v[120:123], v[144:147], v[48:63]
    ds_read_b128 v[112:115], v152 offset:2048
    ds_read_b64 v[116:117], v153 offset:2048
    v_exp_f32 v4, v4
    v_exp_f32 v5, v5
    v_exp_f32 v6, v6
    v_exp_f32 v7, v7
    v_mfma_f32_32x32x16_bf16 v[16:31], v[124:127], v[148:151], v[16:31]
    ds_read_b64_tr_b16 v[136:137], v154 offset:0
    ds_read_b64_tr_b16 v[138:139], v154 offset:128
    v_cvt_pk_bf16_f32 v96, v0, v1
    v_cvt_pk_bf16_f32 v97, v2, v3
    v_cvt_pk_bf16_f32 v98, v4, v5
    v_cvt_pk_bf16_f32 v99, v6, v7
    v_exp_f32 v8, v8
    v_exp_f32 v9, v9
    v_exp_f32 v10, v10
    v_exp_f32 v11, v11
    v_mfma_f32_32x32x16_bf16 v[32:47], v[128:131], v[96:99], v[32:47]
    ds_read_b64_tr_b16 v[140:141], v154 offset:256
    ds_read_b64_tr_b16 v[142:143], v154 offset:384
    s_add_u32 m0, s63, 5120
    s_add_u32 s3, s64, 40960
    buffer_load_dwordx4 v180, s[16:19], s3 offen lds
    v_exp_f32 v12, v12
    v_exp_f32 v13, v13
    v_exp_f32 v14, v14
    v_exp_f32 v15, v15
    v_cvt_pk_bf16_f32 v100, v8, v9
    v_cvt_pk_bf16_f32 v101, v10, v11
    v_cvt_pk_bf16_f32 v102, v12, v13
    v_cvt_pk_bf16_f32 v103, v14, v15
    v_sub_u32 v154, v154, v155
    s_nop 0
    v_mfma_f32_32x32x16_bf16 v[32:47], v[132:135], v[100:103], v[32:47]
    s_cmp_eq_u32 s55, 4
    s_cbranch_scc1 Linv_17
Linvb_18:
    s_add_u32 m0, s63, 6144
    s_add_u32 s3, s64, 40960
    buffer_load_dwordx4 v181, s[16:19], s3 offen lds
    s_waitcnt lgkmcnt(0)
    v_exp_f32 v16, v16
    v_exp_f32 v17, v17
    v_exp_f32 v18, v18
    v_exp_f32 v19, v19
    v_mfma_f32_32x32x16_bf16 v[0:15], v[112:115], v[144:147], v[48:63]
    ds_read_b128 v[120:123], v152 offset:1536
    ds_read_b64 v[124:125], v153 offset:1536
    v_exp_f32 v20, v20
    v_exp_f32 v21, v21
    v_exp_f32 v22, v22
    v_exp_f32 v23, v23
    v_mfma_f32_32x32x16_bf16 v[0:15], v[116:119], v[148:151], v[0:15]
    ds_read_b64_tr_b16 v[128:129], v154 offset:0
    ds_read_b64_tr_b16 v[130:131], v154 offset:128
    v_cvt_pk_bf16_f32 v96, v16, v17
    v_cvt_pk_bf16_f32 v97, v18, v19
    v_cvt_pk_bf16_f32 v98, v20, v21
    v_cvt_pk_bf16_f32 v99, v22, v23
    v_exp_f32 v24, v24
    v_exp_f32 v25, v25
    v_exp_f32 v26, v26
    v_exp_f32 v27, v27
    v_mfma_f32_32x32x16_bf16 v[32:47], v[136:139], v[96:99], v[32:47]
    ds_read_b64_tr_b16 v[132:133], v154 offset:256
    ds_read_b64_tr_b16 v[134:135], v154 offset:384
    s_add_u32 m0, s63, 7168
    s_add_u32 s3, s64, 40960
    buffer_load_dwordx4 v182, s[16:19], s3 offen lds
    v_exp_f32 v28, v28
    v_exp_f32 v29, v29
    v_exp_f32 v30, v30
    v_exp_f32 v31, v31
    v_cvt_pk_bf16_f32 v100, v24, v25
    v_cvt_pk_bf16_f32 v101, v26, v27
    v_cvt_pk_bf16_f32 v102, v28, v29
    v_cvt_pk_bf16_f32 v103, v30, v31
    v_sub_u32 v154, v154, v155
    s_nop 0
    v_mfma_f32_32x32x16_bf16 v[32:47], v[140:143], v[100:103], v[32:47]
    s_cmp_eq_u32 s55, 5
    s_cbranch_scc1 Linv_19
Linvb_20:
    s_add_u32 m0, s63, 8192
    s_add_u32 s3, s64, 40960
    buffer_load_dwordx4 v183, s[16:19], s3 offen lds
    s_waitcnt lgkmcnt(0)
    v_exp_f32 v0, v0
    v_exp_f32 v1, v1
    v_exp_f32 v2, v2
    v_exp_f32 v3, v3
    v_mfma_f32_32x32x16_bf16 v[16:31], v[120:123], v[144:147], v[48:63]
    ds_read_b128 v[112:115], v152 offset:1024
    ds_read_b64 v[116:117], v153 offset:1024
    v_exp_f32 v4, v4
    v_exp_f32 v5, v5
    v_exp_f32 v6, v6
    v_exp_f32 v7, v7
    v_mfma_f32_32x32x16_bf16 v[16:31], v[124:127], v[148:151], v[16:31]
    ds_read_b64_tr_b16 v[136:137], v154 offset:0
    ds_read_b64_tr_b16 v[138:139], v154 offset:128
    v_cvt_pk_bf16_f32 v96, v0, v1
    v_cvt_pk_bf16_f32 v97, v2, v3
    v_cvt_pk_bf16_f32 v98, v4, v5
    v_cvt_pk_bf16_f32 v99, v6, v7
    v_exp_f32 v8, v8
    v_exp_f32 v9, v9
    v_exp_f32 v10, v10
    v_exp_f32 v11, v11
    v_mfma_f32_32x32x16_bf16 v[32:47], v[128:131], v[96:99], v[32:47]
    ds_read_b64_tr_b16 v[140:141], v154 offset:256
    ds_read_b64_tr_b16 v[142:143], v154 offset:384
    s_add_u32 m0, s63, 9216
    s_add_u32 s3, s64, 40960
    buffer_load_dwordx4 v184, s[16:19], s3 offen lds
    v_exp_f32 v12, v12
    v_exp_f32 v13, v13
    v_exp_f32 v14, v14
    v_exp_f32 v15, v15
    v_cvt_pk_bf16_f32 v100, v8, v9
    v_cvt_pk_bf16_f32 v101, v10, v11
    v_cvt_pk_bf16_f32 v102, v12, v13
    v_cvt_pk_bf16_f32 v103, v14, v15
    v_sub_u32 v154, v154, v155
    s_nop 0
    v_mfma_f32_32x32x16_bf16 v[32:47], v[132:135], v[100:103], v[32:47]
    s_cmp_eq_u32 s55, 6
    s_cbranch_scc1 Linv_21
Linvb_22:
    s_add_u32 m0, s63, 10240
    s_add_u32 s3, s64, 81920
    buffer_load_dwordx4 v180, s[16:19], s3 offen lds
    s_waitcnt lgkmcnt(0)
    v_exp_f32 v16, v16
    v_exp_f32 v17, v17
    v_exp_f32 v18, v18
    v_exp_f32 v19, v19
    v_mfma_f32_32x32x16_bf16 v[0:15], v[112:115], v[144:147], v[48:63]
    ds_read_b128 v[120:123], v152 offset:512
    ds_read_b64 v[124:125], v153 offset:512
    v_exp_f32 v20, v20
    v_exp_f32 v21, v21
    v_exp_f32 v22, v22
    v_exp_f32 v23, v23
    v_mfma_f32_32x32x16_bf16 v[0:15], v[116:119], v[148:151], v[0:15]
    ds_read_b64_tr_b16 v[128:129], v154 offset:0
    ds_read_b64_tr_b16 v[130:131], v154 offset:128
    v_cvt_pk_bf16_f32 v96, v16, v17
    v_cvt_pk_bf16_f32 v97, v18, v19
    v_cvt_pk_bf16_f32 v98, v20, v21
    v_cvt_pk_bf16_f32 v99, v22, v23
    v_exp_f32 v24, v24
    v_exp_f32 v25, v25
    v_exp_f32 v26, v26
    v_exp_f32 v27, v27
    v_mfma_f32_32x32x16_bf16 v[32:47], v[136:139], v[96:99], v[32:47]
    ds_read_b64_tr_b16 v[132:133], v154 offset:256
    ds_read_b64_tr_b16 v[134:135], v154 offset:384
    s_add_u32 m0, s63, 11264
    s_add_u32 s3, s64, 81920
    buffer_load_dwordx4 v181, s[16:19], s3 offen lds
    v_exp_f32 v28, v28
    v_exp_f32 v29, v29
    v_exp_f32 v30, v30
    v_exp_f32 v31, v31
    v_cvt_pk_bf16_f32 v100, v24, v25
    v_cvt_pk_bf16_f32 v101, v26, v27
    v_cvt_pk_bf16_f32 v102, v28, v29
    v_cvt_pk_bf16_f32 v103, v30, v31
    v_sub_u32 v154, v154, v155
    s_nop 0
    v_mfma_f32_32x32x16_bf16 v[32:47], v[140:143], v[100:103], v[32:47]
    s_cmp_eq_u32 s55, 7
    s_cbranch_scc1 Linv_23
Linvb_24:
    s_add_u32 m0, s63, 12288
    s_add_u32 s3, s64, 81920
    buffer_load_dwordx4 v182, s[16:19], s3 offen lds
    s_waitcnt lgkmcnt(0)
    v_exp_f32 v0, v0
    v_exp_f32 v1, v1
    v_exp_f32 v2, v2
    v_exp_f32 v3, v3
    v_mfma_f32_32x32x16_bf16 v[16:31], v[120:123], v[144:147], v[48:63]
    v_exp_f32 v4, v4
    v_exp_f32 v5, v5
    v_exp_f32 v6, v6
    v_exp_f32 v7, v7
    v_mfma_f32_32x32x16_bf16 v[16:31], v[124:127], v[148:151], v[16:31]
    ds_read_b64_tr_b16 v[136:137], v154 offset:0
    ds_read_b64_tr_b16 v[138:139], v154 offset:128
    v_cvt_pk_bf16_f32 v96, v0, v1
    v_cvt_pk_bf16_f32 v97, v2, v3
    v_cvt_pk_bf16_f32 v98, v4, v5
    v_cvt_pk_bf16_f32 v99, v6, v7
    v_exp_f32 v8, v8
    v_exp_f32 v9, v9
    v_exp_f32 v10, v10
    v_exp_f32 v11, v11
    v_mfma_f32_32x32x16_bf16 v[32:47], v[128:131], v[96:99], v[32:47]
    ds_read_b64_tr_b16 v[140:141], v154 offset:256
    ds_read_b64_tr_b16 v[142:143], v154 offset:384
    s_add_u32 m0, s63, 13312
    s_add_u32 s3, s64, 81920
    buffer_load_dwordx4 v183, s[16:19], s3 offen lds
    v_exp_f32 v12, v12
    v_exp_f32 v13, v13
    v_exp_f32 v14, v14
    v_exp_f32 v15, v15
    v_cvt_pk_bf16_f32 v100, v8, v9
    v_cvt_pk_bf16_f32 v101, v10, v11
    v_cvt_pk_bf16_f32 v102, v12, v13
    v_cvt_pk_bf16_f32 v103, v14, v15
    s_nop 1
    v_mfma_f32_32x32x16_bf16 v[32:47], v[132:135], v[100:103], v[32:47]
    s_add_u32 m0, s63, 14336
    s_add_u32 s3, s64, 81920
    buffer_load_dwordx4 v184, s[16:19], s3 offen lds
    s_waitcnt lgkmcnt(0)
    v_exp_f32 v16, v16
    v_exp_f32 v17, v17
    v_exp_f32 v18, v18
    v_exp_f32 v19, v19
    v_exp_f32 v20, v20
    v_exp_f32 v21, v21
    v_exp_f32 v22, v22
    v_exp_f32 v23, v23
    v_cvt_pk_bf16_f32 v96, v16, v17
    v_cvt_pk_bf16_f32 v97, v18, v19
    v_cvt_pk_bf16_f32 v98, v20, v21
    v_cvt_pk_bf16_f32 v99, v22, v23
    v_exp_f32 v24, v24
    v_exp_f32 v25, v25
    v_exp_f32 v26, v26
    v_exp_f32 v27, v27
    v_mfma_f32_32x32x16_bf16 v[32:47], v[136:139], v[96:99], v[32:47]
    v_exp_f32 v28, v28
    v_exp_f32 v29, v29
    v_exp_f32 v30, v30
    v_exp_f32 v31, v31
    v_cvt_pk_bf16_f32 v100, v24, v25
    v_cvt_pk_bf16_f32 v101, v26, v27
    v_cvt_pk_bf16_f32 v102, v28, v29
    v_cvt_pk_bf16_f32 v103, v30, v31
    s_nop 1
    v_mfma_f32_32x32x16_bf16 v[32:47], v[140:143], v[100:103], v[32:47]
    s_branch LB_chk
LX_start:
    s_mov_b32 s53, 0
    s_mov_b32 s42, 268435456
    s_mov_b32 s43, 0x20000
    s_mov_b32 s18, 819200
    s_mov_b32 s19, 0x20000
    s_mov_b32 s22, 1280
    s_mov_b32 s23, 0x20000
    s_mov_b32 s26, 2211840
    s_mov_b32 s27, 0x20000
    s_mov_b32 s30, 2211840
    s_mov_b32 s31, 0x20000
    s_mov_b32 s34, 2211840
    s_mov_b32 s35, 0x20000
    s_mov_b32 s38, 2621440
    s_mov_b32 s39, 0x20000
    s_and_b32 s3, s45, 3
    s_lshl2_add_u32 s48, s44, s3
    s_lshr_b32 s49, s45, 2
    s_lshl_b32 s51, s44, 4
    s_sub_u32 s51, s51, 16
    s_lshl_b32 s3, s44, 3
    s_lshl_b32 s60, s44, 2
    s_sub_u32 s60, s60, 8
    s_sub_u32 s61, s3, 8
    s_cmp_lt_u32 s44, 2
    s_cselect_b32 s51, s3, s51
    s_cselect_b32 s60, s61, s60
    s_cselect_b32 s3, 8, 16
    s_cselect_b32 s61, 16, 20
    s_cmp_lt_u32 s45, s61
    s_cselect_b32 s50, 1, 2
    s_cmp_lt_u32 s45, s3
    s_cselect_b32 s51, s51, s60
    s_cselect_b32 s50, 0, s50
    s_add_u32 s51, s51, s45
    s_cmp_ge_u32 s51, 108
    s_cselect_b32 s50, 2, s50
    s_mul_i32 s60, s49, 160
    s_xor_b32 s3, s53, 0
    s_lshl_b32 s3, s3, 5
    s_add_u32 s3, s3, s48
    s_lshl2_add_u32 s61, s3, s52
    s_mul_i32 s61, s61, 10240
    s_add_u32 s61, s61, s60
    s_lshl_b32 s62, s48, 13
    s_add_u32 s62, s62, 1048576
    s_mul_i32 s64, s52, 204800
    s_add_u32 s64, s64, s60
    s_mul_i32 s63, s52, 21504
    s_add_u32 s63, s63, 74752
    v_mov_b32 v16, -1
    v_mov_b32 v17, -1
    v_mov_b32 v18, -1
    v_mov_b32 v19, -1
    v_and_b32 v4, 7, v255
    v_lshrrev_b32 v5, 3, v255
    v_lshlrev_b32 v4, 4, v4
    s_lshl_b32 s67, s46, 6
    s_lshl2_add_u32 s67, s47, s67
    s_lshl_b32 s67, s67, 7
    s_add_u32 s67, s67, 65536
    s_lshl_b32 s69, s49, 7
    s_add_u32 s69, s69, s48
    s_lshl_b32 s69, s69, 7
    s_add_u32 s69, s69, 327680
    s_lshl_b32 s70, s49, 7
    s_add_u32 s70, s70, s62
    s_and_b32 s3, s52, 1
    s_lshl_b32 s3, s3, 18
    s_add_u32 s70, s70, s3
    s_cmp_eq_u32 s52, 0
    s_cselect_b32 s69, s67, s69
    s_cselect_b32 s71, 7, 12
    s_cmp_ge_u32 s52, 2
    s_cselect_b32 s69, s70, s69
    s_cselect_b32 s71, 10, s71
    s_cselect_b32 s72, 12, 17
    v_and_b32 v6, 3, v5
    v_lshlrev_b32 v6, s71, v6
    v_lshrrev_b32 v9, 2, v5
    v_lshlrev_b32 v9, s72, v9
    v_add3_u32 v6, v6, v9, v4
    s_lshl_b32 s70, s2, 7
    s_add_u32 s73, s70, 655360
    s_add_u32 s70, s70, 589824
    s_cmp_eq_u32 s52, 0
    s_cselect_b32 s73, s73, s70
    s_lshl1_add_u32 s71, s48, s52
    s_lshl_b32 s71, s71, 7
    s_add_u32 s71, s71, 622336
    s_and_b32 s3, s48, 7
    s_cmp_eq_u32 s3, s49
    s_cselect_b32 s71, s71, s70
    s_cmp_ge_u32 s52, 2
    s_cselect_b32 s73, s71, s73
    s_and_b32 s3, s44, 1
    s_lshl_b32 s3, s3, 5
    s_add_u32 s3, s3, s45
    s_mul_i32 s3, s3, 10
    s_add_u32 s3, s3, s52
    s_mul_i32 s74, s3, 3840
    s_lshr_b32 s3, s44, 1
    s_mul_i32 s3, s3, 15
    s_add_u32 s3, s3, 1
    s_lshr_b32 s3, s3, 1
    s_lshl_b32 s3, s3, 7
    s_add_u32 s74, s74, s3
    s_mov_b32 s76, 0x00ff00ff
    s_bitcmp1_b32 s44, 1
    s_cselect_b32 s76, 0x007f007f, s76
    v_lshrrev_b32 v7, 4, v255
    v_mul_u32_u24 v7, 15360, v7
    v_and_b32 v8, 15, v255
    v_lshl_add_u32 v7, v8, 7, v7
    s_lshr_b32 s75, s76, 16
    s_cmp_lt_u32 s52, 2
    s_cselect_b32 s75, s75, 0
    s_waitcnt lgkmcnt(0)
    s_mov_b32 exec_lo, s76
    s_mov_b32 exec_hi, s75
    buffer_load_dword v253, v7, s[12:15], s74 offen
    s_mov_b64 exec, -1
    s_sub_u32 s3, s52, 1
    s_cmp_lt_u32 s3, 2
    s_cbranch_scc1 LX_nomark
    buffer_store_dwordx4 v[16:19], v6, s[40:43], s69 offen sc1
LX_nomark:
    s_mov_b64 exec, 0xff
    buffer_store_dwordx4 v[16:19], v4, s[40:43], s73 offen sc1
    s_mov_b64 exec, -1
    s_load_dword s6, s[40:41], 0
    s_load_dwordx2 s[32:33], s[0:1], 56
    s_load_dwordx2 s[36:37], s[0:1], 64
    s_load_dwordx2 s[16:17], s[0:1], 16
    s_load_dwordx2 s[20:21], s[0:1], 32
    s_load_dwordx2 s[24:25], s[0:1], 40
    s_load_dwordx2 s[28:29], s[0:1], 48
    s_lshl_b32 s3, s52, 7
    s_add_u32 s67, s67, s3
    v_mov_b32 v5, 0
    v_lshlrev_b32 v4, 2, v255
    v_mov_b32 v3, 0x3f803f80
    v_add_u32 v4, 160768, v4
    v_and_b32 v3, 1, v255
    v_sub_u32 v3, 1, v3
    v_mul_u32_u24 v3, 0x3f80, v3
    ds_write_b32 v4, v5
    ds_write_b32 v4, v5 offset:256
    ds_write_b32 v4, v3 offset:1024
    ds_write_b32 v4, v3 offset:1280
    ds_write_b32 v4, v3 offset:1536
    ds_write_b32 v4, v3 offset:1792
    v_mov_b32 v240, 0x3f803f80
    v_mov_b32 v241, 0x3f803f80
    v_mov_b32 v242, 0x3f803f80
    v_mov_b32 v243, 0x3f803f80
    v_lshrrev_b32 v1, 4, v255
    v_and_b32 v2, 15, v255
    v_bfe_u32 v4, v255, 2, 2
    v_lshl_add_u32 v3, v1, 3, v4
    v_lshlrev_b32 v248, 8, v3
    v_xor_b32 v3, s52, v4
    v_lshl_add_u32 v248, v3, 6, v248
    v_and_b32 v3, 3, v255
    v_lshl_add_u32 v248, v3, 4, v248
    v_bfe_u32 v3, v255, 1, 3
    v_xor_b32 v3, v3, v1
    v_lshlrev_b32 v6, 7, v2
    v_lshl_add_u32 v6, v3, 4, v6
    v_add_u32 v244, 49152, v6
    v_xor_b32 v245, 64, v244
    v_mul_u32_u24 v249, 32768, v1
    v_lshl_add_u32 v249, v2, 4, v249
    s_cmp_lt_u32 s47, 5
    s_cselect_b32 s57, 0x3ea52b5c, 1.0
    s_cselect_b32 s59, -2, -1
    s_cselect_b32 s56, 0x8000, 0
    s_lshl2_add_u32 s3, s47, s52
    s_mul_i32 s58, s3, 131072
    s_lshl_b32 s3, s46, 10
    s_add_u32 s58, s58, s3
    s_add_u32 s58, s58, 16777216
    s_waitcnt lgkmcnt(0)
    s_mul_i32 s6, s6, 1664525
    s_add_u32 s6, s6, 1013904223
    s_bitset0_b32 s6, 31
    s_cmp_eq_u32 s47, 15
    s_cbranch_scc1 LX_skipA
    s_barrier
    ds_read_b64_tr_b16 v[0:1], v248 offset:0
    ds_read_b64_tr_b16 v[2:3], v248 offset:1024
    ds_read_b64_tr_b16 v[4:5], v248 offset:8
    ds_read_b64_tr_b16 v[6:7], v248 offset:1032
    ds_read_b128 v[208:211], v244 offset:0
    ds_read_b128 v[212:215], v244 offset:2048
    ds_read_b128 v[216:219], v244 offset:4096
    ds_read_b128 v[220:223], v244 offset:6144
    ds_read_b64_tr_b16 v[8:9], v248 offset:8192
    ds_read_b64_tr_b16 v[10:11], v248 offset:9216
    ds_read_b64_tr_b16 v[12:13], v248 offset:8200
    ds_read_b64_tr_b16 v[14:15], v248 offset:9224
    ds_read_b128 v[224:227], v245 offset:0
    ds_read_b128 v[228:231], v245 offset:2048
    s_waitcnt lgkmcnt(8)
    v_mfma_f32_16x16x32_bf16 v[160:163], v[0:3], v[208:211], 0
    v_mfma_f32_16x16x32_bf16 v[164:167], v[4:7], v[208:211], 0
    v_mfma_f32_16x16x32_bf16 v[168:171], v[0:3], v[212:215], 0
    v_mfma_f32_16x16x32_bf16 v[172:175], v[4:7], v[212:215], 0
    v_mfma_f32_16x16x32_bf16 v[192:195], v[0:3], v[240:243], 0
    ds_read_b128 v[232:235], v245 offset:4096
    ds_read_b128 v[236:239], v245 offset:6144
    s_waitcnt lgkmcnt(8)
    v_mfma_f32_16x16x32_bf16 v[176:179], v[0:3], v[216:219], 0
    v_mfma_f32_16x16x32_bf16 v[180:183], v[4:7], v[216:219], 0
    v_mfma_f32_16x16x32_bf16 v[184:187], v[0:3], v[220:223], 0
    v_mfma_f32_16x16x32_bf16 v[188:191], v[4:7], v[220:223], 0
    v_mfma_f32_16x16x32_bf16 v[196:199], v[4:7], v[240:243], 0
    s_waitcnt lgkmcnt(0)
    s_barrier
    ds_read_b64_tr_b16 v[16:17], v248 offset:16384
    ds_read_b64_tr_b16 v[18:19], v248 offset:17408
    ds_read_b64_tr_b16 v[20:21], v248 offset:16392
    ds_read_b64_tr_b16 v[22:23], v248 offset:17416
    ds_read_b128 v[208:211], v244 offset:8192
    ds_read_b128 v[212:215], v244 offset:10240
    ds_read_b128 v[216:219], v244 offset:12288
    ds_read_b128 v[220:223], v244 offset:14336
    v_mfma_f32_16x16x32_bf16 v[160:163], v[8:11], v[224:227], v[160:163]
    v_mfma_f32_16x16x32_bf16 v[164:167], v[12:15], v[224:227], v[164:167]
    v_mfma_f32_16x16x32_bf16 v[168:171], v[8:11], v[228:231], v[168:171]
    v_mfma_f32_16x16x32_bf16 v[172:175], v[12:15], v[228:231], v[172:175]
    v_mfma_f32_16x16x32_bf16 v[192:195], v[8:11], v[240:243], v[192:195]
    v_mfma_f32_16x16x32_bf16 v[176:179], v[8:11], v[232:235], v[176:179]
    v_mfma_f32_16x16x32_bf16 v[180:183], v[12:15], v[232:235], v[180:183]
    v_mfma_f32_16x16x32_bf16 v[184:187], v[8:11], v[236:239], v[184:187]
    v_mfma_f32_16x16x32_bf16 v[188:191], v[12:15], v[236:239], v[188:191]
    v_mfma_f32_16x16x32_bf16 v[196:199], v[12:15], v[240:243], v[196:199]
    ds_read_b64_tr_b16 v[24:25], v248 offset:24576
    ds_read_b64_tr_b16 v[26:27], v248 offset:25600
    ds_read_b64_tr_b16 v[28:29], v248 offset:24584
    ds_read_b64_tr_b16 v[30:31], v248 offset:25608
    ds_read_b128 v[224:227], v245 offset:8192
    ds_read_b128 v[228:231], v245 offset:10240
    s_waitcnt lgkmcnt(8)
    v_mfma_f32_16x16x32_bf16 v[160:163], v[16:19], v[208:211], v[160:163]
    v_mfma_f32_16x16x32_bf16 v[164:167], v[20:23], v[208:211], v[164:167]
    v_mfma_f32_16x16x32_bf16 v[168:171], v[16:19], v[212:215], v[168:171]
    v_mfma_f32_16x16x32_bf16 v[172:175], v[20:23], v[212:215], v[172:175]
    v_mfma_f32_16x16x32_bf16 v[192:195], v[16:19], v[240:243], v[192:195]
    ds_read_b128 v[232:235], v245 offset:12288
    ds_read_b128 v[236:239], v245 offset:14336
    s_waitcnt lgkmcnt(8)
    v_mfma_f32_16x16x32_bf16 v[176:179], v[16:19], v[216:219], v[176:179]
    v_mfma_f32_16x16x32_bf16 v[180:183], v[20:23], v[216:219], v[180:183]
    v_mfma_f32_16x16x32_bf16 v[184:187], v[16:19], v[220:223], v[184:187]
    v_mfma_f32_16x16x32_bf16 v[188:191], v[20:23], v[220:223], v[188:191]
    v_mfma_f32_16x16x32_bf16 v[196:199], v[20:23], v[240:243], v[196:199]
    s_waitcnt lgkmcnt(0)
    s_barrier
    ds_read_b64_tr_b16 v[32:33], v248 offset:32768
    ds_read_b64_tr_b16 v[34:35], v248 offset:33792
    ds_read_b64_tr_b16 v[36:37], v248 offset:32776
    ds_read_b64_tr_b16 v[38:39], v248 offset:33800
    ds_read_b128 v[208:211], v244 offset:16384
    ds_read_b128 v[212:215], v244 offset:18432
    ds_read_b128 v[216:219], v244 offset:20480
    ds_read_b128 v[220:223], v244 offset:22528
    v_mfma_f32_16x16x32_bf16 v[160:163], v[24:27], v[224:227], v[160:163]
    v_mfma_f32_16x16x32_bf16 v[164:167], v[28:31], v[224:227], v[164:167]
    v_mfma_f32_16x16x32_bf16 v[168:171], v[24:27], v[228:231], v[168:171]
    v_mfma_f32_16x16x32_bf16 v[172:175], v[28:31], v[228:231], v[172:175]
    v_mfma_f32_16x16x32_bf16 v[192:195], v[24:27], v[240:243], v[192:195]
    v_mfma_f32_16x16x32_bf16 v[176:179], v[24:27], v[232:235], v[176:179]
    v_mfma_f32_16x16x32_bf16 v[180:183], v[28:31], v[232:235], v[180:183]
    v_mfma_f32_16x16x32_bf16 v[184:187], v[24:27], v[236:239], v[184:187]
    v_mfma_f32_16x16x32_bf16 v[188:191], v[28:31], v[236:239], v[188:191]
    v_mfma_f32_16x16x32_bf16 v[196:199], v[28:31], v[240:243], v[196:199]
    ds_read_b64_tr_b16 v[40:41], v248 offset:40960
    ds_read_b64_tr_b16 v[42:43], v248 offset:41984
    ds_read_b64_tr_b16 v[44:45], v248 offset:40968
    ds_read_b64_tr_b16 v[46:47], v248 offset:41992
    ds_read_b128 v[224:227], v245 offset:16384
    ds_read_b128 v[228:231], v245 offset:18432
    s_waitcnt lgkmcnt(8)
    v_mfma_f32_16x16x32_bf16 v[160:163], v[32:35], v[208:211], v[160:163]
    v_mfma_f32_16x16x32_bf16 v[164:167], v[36:39], v[208:211], v[164:167]
    v_mfma_f32_16x16x32_bf16 v[168:171], v[32:35], v[212:215], v[168:171]
    v_mfma_f32_16x16x32_bf16 v[172:175], v[36:39], v[212:215], v[172:175]
    v_mfma_f32_16x16x32_bf16 v[192:195], v[32:35], v[240:243], v[192:195]
    ds_read_b128 v[232:235], v245 offset:20480
    ds_read_b128 v[236:239], v245 offset:22528
    s_waitcnt lgkmcnt(8)
    v_mfma_f32_16x16x32_bf16 v[176:179], v[32:35], v[216:219], v[176:179]
    v_mfma_f32_16x16x32_bf16 v[180:183], v[36:39], v[216:219], v[180:183]
    v_mfma_f32_16x16x32_bf16 v[184:187], v[32:35], v[220:223], v[184:187]
    v_mfma_f32_16x16x32_bf16 v[188:191], v[36:39], v[220:223], v[188:191]
    v_mfma_f32_16x16x32_bf16 v[196:199], v[36:39], v[240:243], v[196:199]
    s_waitcnt lgkmcnt(0)
    s_barrier
    ds_read_b64_tr_b16 v[48:49], v248 offset:0
    ds_read_b64_tr_b16 v[50:51], v248 offset:1024
    ds_read_b64_tr_b16 v[52:53], v248 offset:8
    ds_read_b64_tr_b16 v[54:55], v248 offset:1032
    ds_read_b128 v[208:211], v244 offset:0
    ds_read_b128 v[212:215], v244 offset:2048
    ds_read_b128 v[216:219], v244 offset:4096
    ds_read_b128 v[220:223], v244 offset:6144
    v_mfma_f32_16x16x32_bf16 v[160:163], v[40:43], v[224:227], v[160:163]
    v_mfma_f32_16x16x32_bf16 v[164:167], v[44:47], v[224:227], v[164:167]
    v_mfma_f32_16x16x32_bf16 v[168:171], v[40:43], v[228:231], v[168:171]
    v_mfma_f32_16x16x32_bf16 v[172:175], v[44:47], v[228:231], v[172:175]
    v_mfma_f32_16x16x32_bf16 v[192:195], v[40:43], v[240:243], v[192:195]
    v_mfma_f32_16x16x32_bf16 v[176:179], v[40:43], v[232:235], v[176:179]
    v_mfma_f32_16x16x32_bf16 v[180:183], v[44:47], v[232:235], v[180:183]
    v_mfma_f32_16x16x32_bf16 v[184:187], v[40:43], v[236:239], v[184:187]
    v_mfma_f32_16x16x32_bf16 v[188:191], v[44:47], v[236:239], v[188:191]
    v_mfma_f32_16x16x32_bf16 v[196:199], v[44:47], v[240:243], v[196:199]
    ds_read_b64_tr_b16 v[56:57], v248 offset:8192
    ds_read_b64_tr_b16 v[58:59], v248 offset:9216
    ds_read_b64_tr_b16 v[60:61], v248 offset:8200
    ds_read_b64_tr_b16 v[62:63], v248 offset:9224
    ds_read_b128 v[224:227], v245 offset:0
    ds_read_b128 v[228:231], v245 offset:2048
    s_waitcnt lgkmcnt(8)
    v_mfma_f32_16x16x32_bf16 v[160:163], v[48:51], v[208:211], v[160:163]
    v_mfma_f32_16x16x32_bf16 v[164:167], v[52:55], v[208:211], v[164:167]
    v_mfma_f32_16x16x32_bf16 v[168:171], v[48:51], v[212:215], v[168:171]
    v_mfma_f32_16x16x32_bf16 v[172:175], v[52:55], v[212:215], v[172:175]
    v_mfma_f32_16x16x32_bf16 v[192:195], v[48:51], v[240:243], v[192:195]
    ds_read_b128 v[232:235], v245 offset:4096
    ds_read_b128 v[236:239], v245 offset:6144
    s_waitcnt lgkmcnt(8)
    v_mfma_f32_16x16x32_bf16 v[176:179], v[48:51], v[216:219], v[176:179]
    v_mfma_f32_16x16x32_bf16 v[180:183], v[52:55], v[216:219], v[180:183]
    v_mfma_f32_16x16x32_bf16 v[184:187], v[48:51], v[220:223], v[184:187]
    v_mfma_f32_16x16x32_bf16 v[188:191], v[52:55], v[220:223], v[188:191]
    v_mfma_f32_16x16x32_bf16 v[196:199], v[52:55], v[240:243], v[196:199]
    s_waitcnt lgkmcnt(0)
    s_barrier
    ds_read_b64_tr_b16 v[64:65], v248 offset:16384
    ds_read_b64_tr_b16 v[66:67], v248 offset:17408
    ds_read_b64_tr_b16 v[68:69], v248 offset:16392
    ds_read_b64_tr_b16 v[70:71], v248 offset:17416
    ds_read_b128 v[208:211], v244 offset:8192
    ds_read_b128 v[212:215], v244 offset:10240
    ds_read_b128 v[216:219], v244 offset:12288
    ds_read_b128 v[220:223], v244 offset:14336
    v_mfma_f32_16x16x32_bf16 v[160:163], v[56:59], v[224:227], v[160:163]
    v_mfma_f32_16x16x32_bf16 v[164:167], v[60:63], v[224:227], v[164:167]
    v_mfma_f32_16x16x32_bf16 v[168:171], v[56:59], v[228:231], v[168:171]
    v_mfma_f32_16x16x32_bf16 v[172:175], v[60:63], v[228:231], v[172:175]
    v_mfma_f32_16x16x32_bf16 v[192:195], v[56:59], v[240:243], v[192:195]
    v_mfma_f32_16x16x32_bf16 v[176:179], v[56:59], v[232:235], v[176:179]
    v_mfma_f32_16x16x32_bf16 v[180:183], v[60:63], v[232:235], v[180:183]
    v_mfma_f32_16x16x32_bf16 v[184:187], v[56:59], v[236:239], v[184:187]
    v_mfma_f32_16x16x32_bf16 v[188:191], v[60:63], v[236:239], v[188:191]
    v_mfma_f32_16x16x32_bf16 v[196:199], v[60:63], v[240:243], v[196:199]
    ds_read_b64_tr_b16 v[72:73], v248 offset:24576
    ds_read_b64_tr_b16 v[74:75], v248 offset:25600
    ds_read_b64_tr_b16 v[76:77], v248 offset:24584
    ds_read_b64_tr_b16 v[78:79], v248 offset:25608
    ds_read_b128 v[224:227], v245 offset:8192
    ds_read_b128 v[228:231], v245 offset:10240
    s_waitcnt lgkmcnt(8)
    v_mfma_f32_16x16x32_bf16 v[160:163], v[64:67], v[208:211], v[160:163]
    v_mfma_f32_16x16x32_bf16 v[164:167], v[68:71], v[208:211], v[164:167]
    v_mfma_f32_16x16x32_bf16 v[168:171], v[64:67], v[212:215], v[168:171]
    v_mfma_f32_16x16x32_bf16 v[172:175], v[68:71], v[212:215], v[172:175]
    v_mfma_f32_16x16x32_bf16 v[192:195], v[64:67], v[240:243], v[192:195]
    ds_read_b128 v[232:235], v245 offset:12288
    ds_read_b128 v[236:239], v245 offset:14336
    s_waitcnt lgkmcnt(8)
    v_mfma_f32_16x16x32_bf16 v[176:179], v[64:67], v[216:219], v[176:179]
    v_mfma_f32_16x16x32_bf16 v[180:183], v[68:71], v[216:219], v[180:183]
    v_mfma_f32_16x16x32_bf16 v[184:187], v[64:67], v[220:223], v[184:187]
    v_mfma_f32_16x16x32_bf16 v[188:191], v[68:71], v[220:223], v[188:191]
    v_mfma_f32_16x16x32_bf16 v[196:199], v[68:71], v[240:243], v[196:199]
    s_waitcnt lgkmcnt(0)
    s_barrier
    ds_read_b64_tr_b16 v[80:81], v248 offset:32768
    ds_read_b64_tr_b16 v[82:83], v248 offset:33792
    ds_read_b64_tr_b16 v[84:85], v248 offset:32776
    ds_read_b64_tr_b16 v[86:87], v248 offset:33800
    ds_read_b128 v[208:211], v244 offset:16384
    ds_read_b128 v[212:215], v244 offset:18432
    ds_read_b128 v[216:219], v244 offset:20480
    ds_read_b128 v[220:223], v244 offset:22528
    v_mfma_f32_16x16x32_bf16 v[160:163], v[72:75], v[224:227], v[160:163]
    v_mfma_f32_16x16x32_bf16 v[164:167], v[76:79], v[224:227], v[164:167]
    v_mfma_f32_16x16x32_bf16 v[168:171], v[72:75], v[228:231], v[168:171]
    v_mfma_f32_16x16x32_bf16 v[172:175], v[76:79], v[228:231], v[172:175]
    v_mfma_f32_16x16x32_bf16 v[192:195], v[72:75], v[240:243], v[192:195]
    v_mfma_f32_16x16x32_bf16 v[176:179], v[72:75], v[232:235], v[176:179]
    v_mfma_f32_16x16x32_bf16 v[180:183], v[76:79], v[232:235], v[180:183]
    v_mfma_f32_16x16x32_bf16 v[184:187], v[72:75], v[236:239], v[184:187]
    v_mfma_f32_16x16x32_bf16 v[188:191], v[76:79], v[236:239], v[188:191]
    v_mfma_f32_16x16x32_bf16 v[196:199], v[76:79], v[240:243], v[196:199]
    ds_read_b64_tr_b16 v[88:89], v248 offset:40960
    ds_read_b64_tr_b16 v[90:91], v248 offset:41984
    ds_read_b64_tr_b16 v[92:93], v248 offset:40968
    ds_read_b64_tr_b16 v[94:95], v248 offset:41992
    ds_read_b128 v[224:227], v245 offset:16384
    ds_read_b128 v[228:231], v245 offset:18432
    s_waitcnt lgkmcnt(8)
    v_mfma_f32_16x16x32_bf16 v[160:163], v[80:83], v[208:211], v[160:163]
    v_mfma_f32_16x16x32_bf16 v[164:167], v[84:87], v[208:211], v[164:167]
    v_mfma_f32_16x16x32_bf16 v[168:171], v[80:83], v[212:215], v[168:171]
    v_mfma_f32_16x16x32_bf16 v[172:175], v[84:87], v[212:215], v[172:175]
    v_mfma_f32_16x16x32_bf16 v[192:195], v[80:83], v[240:243], v[192:195]
    ds_read_b128 v[232:235], v245 offset:20480
    ds_read_b128 v[236:239], v245 offset:22528
    s_waitcnt lgkmcnt(8)
    v_mfma_f32_16x16x32_bf16 v[176:179], v[80:83], v[216:219], v[176:179]
    v_mfma_f32_16x16x32_bf16 v[180:183], v[84:87], v[216:219], v[180:183]
    v_mfma_f32_16x16x32_bf16 v[184:187], v[80:83], v[220:223], v[184:187]
    v_mfma_f32_16x16x32_bf16 v[188:191], v[84:87], v[220:223], v[188:191]
    v_mfma_f32_16x16x32_bf16 v[196:199], v[84:87], v[240:243], v[196:199]
    s_waitcnt lgkmcnt(0)
    s_barrier
    ds_read_b64_tr_b16 v[96:97], v248 offset:0
    ds_read_b64_tr_b16 v[98:99], v248 offset:1024
    ds_read_b64_tr_b16 v[100:101], v248 offset:8
    ds_read_b64_tr_b16 v[102:103], v248 offset:1032
    ds_read_b128 v[208:211], v244 offset:0
    ds_read_b128 v[212:215], v244 offset:2048
    ds_read_b128 v[216:219], v244 offset:4096
    ds_read_b128 v[220:223], v244 offset:6144
    v_mfma_f32_16x16x32_bf16 v[160:163], v[88:91], v[224:227], v[160:163]
    v_mfma_f32_16x16x32_bf16 v[164:167], v[92:95], v[224:227], v[164:167]
    v_mfma_f32_16x16x32_bf16 v[168:171], v[88:91], v[228:231], v[168:171]
    v_mfma_f32_16x16x32_bf16 v[172:175], v[92:95], v[228:231], v[172:175]
    v_mfma_f32_16x16x32_bf16 v[192:195], v[88:91], v[240:243], v[192:195]
    v_mfma_f32_16x16x32_bf16 v[176:179], v[88:91], v[232:235], v[176:179]
    v_mfma_f32_16x16x32_bf16 v[180:183], v[92:95], v[232:235], v[180:183]
    v_mfma_f32_16x16x32_bf16 v[184:187], v[88:91], v[236:239], v[184:187]
    v_mfma_f32_16x16x32_bf16 v[188:191], v[92:95], v[236:239], v[188:191]
    v_mfma_f32_16x16x32_bf16 v[196:199], v[92:95], v[240:243], v[196:199]
    ds_read_b64_tr_b16 v[104:105], v248 offset:8192
    ds_read_b64_tr_b16 v[106:107], v248 offset:9216
    ds_read_b64_tr_b16 v[108:109], v248 offset:8200
    ds_read_b64_tr_b16 v[110:111], v248 offset:9224
    ds_read_b128 v[224:227], v245 offset:0
    ds_read_b128 v[228:231], v245 offset:2048
    s_waitcnt lgkmcnt(8)
    v_mfma_f32_16x16x32_bf16 v[160:163], v[96:99], v[208:211], v[160:163]
    v_mfma_f32_16x16x32_bf16 v[164:167], v[100:103], v[208:211], v[164:167]
    v_mfma_f32_16x16x32_bf16 v[168:171], v[96:99], v[212:215], v[168:171]
    v_mfma_f32_16x16x32_bf16 v[172:175], v[100:103], v[212:215], v[172:175]
    v_mfma_f32_16x16x32_bf16 v[192:195], v[96:99], v[240:243], v[192:195]
    ds_read_b128 v[232:235], v245 offset:4096
    ds_read_b128 v[236:239], v245 offset:6144
    s_waitcnt lgkmcnt(8)
    v_mfma_f32_16x16x32_bf16 v[176:179], v[96:99], v[216:219], v[176:179]
    v_mfma_f32_16x16x32_bf16 v[180:183], v[100:103], v[216:219], v[180:183]
    v_mfma_f32_16x16x32_bf16 v[184:187], v[96:99], v[220:223], v[184:187]
    v_mfma_f32_16x16x32_bf16 v[188:191], v[100:103], v[220:223], v[188:191]
    v_mfma_f32_16x16x32_bf16 v[196:199], v[100:103], v[240:243], v[196:199]
    s_waitcnt lgkmcnt(0)
    s_waitcnt vmcnt(0)
    s_barrier
    ds_read_b64_tr_b16 v[112:113], v248 offset:16384
    ds_read_b64_tr_b16 v[114:115], v248 offset:17408
    ds_read_b64_tr_b16 v[116:117], v248 offset:16392
    ds_read_b64_tr_b16 v[118:119], v248 offset:17416
    ds_read_b128 v[208:211], v244 offset:8192
    ds_read_b128 v[212:215], v244 offset:10240
    ds_read_b128 v[216:219], v244 offset:12288
    ds_read_b128 v[220:223], v244 offset:14336
    v_mfma_f32_16x16x32_bf16 v[160:163], v[104:107], v[224:227], v[160:163]
    v_mfma_f32_16x16x32_bf16 v[164:167], v[108:111], v[224:227], v[164:167]
    v_mfma_f32_16x16x32_bf16 v[168:171], v[104:107], v[228:231], v[168:171]
    v_mfma_f32_16x16x32_bf16 v[172:175], v[108:111], v[228:231], v[172:175]
    v_mfma_f32_16x16x32_bf16 v[192:195], v[104:107], v[240:243], v[192:195]
    v_mfma_f32_16x16x32_bf16 v[176:179], v[104:107], v[232:235], v[176:179]
    v_mfma_f32_16x16x32_bf16 v[180:183], v[108:111], v[232:235], v[180:183]
    v_mfma_f32_16x16x32_bf16 v[184:187], v[104:107], v[236:239], v[184:187]
    v_mfma_f32_16x16x32_bf16 v[188:191], v[108:111], v[236:239], v[188:191]
    v_mfma_f32_16x16x32_bf16 v[196:199], v[108:111], v[240:243], v[196:199]
    ds_read_b64_tr_b16 v[120:121], v248 offset:24576
    ds_read_b64_tr_b16 v[122:123], v248 offset:25600
    ds_read_b64_tr_b16 v[124:125], v248 offset:24584
    ds_read_b64_tr_b16 v[126:127], v248 offset:25608
    ds_read_b128 v[224:227], v245 offset:8192
    ds_read_b128 v[228:231], v245 offset:10240
    s_waitcnt lgkmcnt(8)
    v_mfma_f32_16x16x32_bf16 v[160:163], v[112:115], v[208:211], v[160:163]
    v_mfma_f32_16x16x32_bf16 v[164:167], v[116:119], v[208:211], v[164:167]
    v_mfma_f32_16x16x32_bf16 v[168:171], v[112:115], v[212:215], v[168:171]
    v_mfma_f32_16x16x32_bf16 v[172:175], v[116:119], v[212:215], v[172:175]
    v_mfma_f32_16x16x32_bf16 v[192:195], v[112:115], v[240:243], v[192:195]
    ds_read_b128 v[232:235], v245 offset:12288
    ds_read_b128 v[236:239], v245 offset:14336
    s_waitcnt lgkmcnt(8)
    v_mfma_f32_16x16x32_bf16 v[176:179], v[112:115], v[216:219], v[176:179]
    v_mfma_f32_16x16x32_bf16 v[180:183], v[116:119], v[216:219], v[180:183]
    v_mfma_f32_16x16x32_bf16 v[184:187], v[112:115], v[220:223], v[184:187]
    v_mfma_f32_16x16x32_bf16 v[188:191], v[116:119], v[220:223], v[188:191]
    v_mfma_f32_16x16x32_bf16 v[196:199], v[116:119], v[240:243], v[196:199]
    s_waitcnt lgkmcnt(0)
    s_barrier
    ds_read_b64_tr_b16 v[128:129], v248 offset:32768
    ds_read_b64_tr_b16 v[130:131], v248 offset:33792
    ds_read_b64_tr_b16 v[132:133], v248 offset:32776
    ds_read_b64_tr_b16 v[134:135], v248 offset:33800
    ds_read_b128 v[208:211], v244 offset:16384
    ds_read_b128 v[212:215], v244 offset:18432
    ds_read_b128 v[216:219], v244 offset:20480
    ds_read_b128 v[220:223], v244 offset:22528
    v_mfma_f32_16x16x32_bf16 v[160:163], v[120:123], v[224:227], v[160:163]
    v_mfma_f32_16x16x32_bf16 v[164:167], v[124:127], v[224:227], v[164:167]
    v_mfma_f32_16x16x32_bf16 v[168:171], v[120:123], v[228:231], v[168:171]
    v_mfma_f32_16x16x32_bf16 v[172:175], v[124:127], v[228:231], v[172:175]
    v_mfma_f32_16x16x32_bf16 v[192:195], v[120:123], v[240:243], v[192:195]
    v_mfma_f32_16x16x32_bf16 v[176:179], v[120:123], v[232:235], v[176:179]
    v_mfma_f32_16x16x32_bf16 v[180:183], v[124:127], v[232:235], v[180:183]
    v_mfma_f32_16x16x32_bf16 v[184:187], v[120:123], v[236:239], v[184:187]
    v_mfma_f32_16x16x32_bf16 v[188:191], v[124:127], v[236:239], v[188:191]
    v_mfma_f32_16x16x32_bf16 v[196:199], v[124:127], v[240:243], v[196:199]
    ds_read_b64_tr_b16 v[136:137], v248 offset:40960
    ds_read_b64_tr_b16 v[138:139], v248 offset:41984
    ds_read_b64_tr_b16 v[140:141], v248 offset:40968
    ds_read_b64_tr_b16 v[142:143], v248 offset:41992
    ds_read_b128 v[224:227], v245 offset:16384
    ds_read_b128 v[228:231], v245 offset:18432
    s_waitcnt lgkmcnt(8)
    v_mfma_f32_16x16x32_bf16 v[160:163], v[128:131], v[208:211], v[160:163]
    v_mfma_f32_16x16x32_bf16 v[164:167], v[132:135], v[208:211], v[164:167]
    v_mfma_f32_16x16x32_bf16 v[168:171], v[128:131], v[212:215], v[168:171]
    v_mfma_f32_16x16x32_bf16 v[172:175], v[132:135], v[212:215], v[172:175]
    v_mfma_f32_16x16x32_bf16 v[192:195], v[128:131], v[240:243], v[192:195]
    ds_read_b128 v[232:235], v245 offset:20480
    ds_read_b128 v[236:239], v245 offset:22528
    s_waitcnt lgkmcnt(8)
    v_mfma_f32_16x16x32_bf16 v[176:179], v[128:131], v[216:219], v[176:179]
    v_mfma_f32_16x16x32_bf16 v[180:183], v[132:135], v[216:219], v[180:183]
    v_mfma_f32_16x16x32_bf16 v[184:187], v[128:131], v[220:223], v[184:187]
    v_mfma_f32_16x16x32_bf16 v[188:191], v[132:135], v[220:223], v[188:191]
    v_mfma_f32_16x16x32_bf16 v[196:199], v[132:135], v[240:243], v[196:199]
    s_waitcnt lgkmcnt(0)
    s_barrier
    ds_read_b64_tr_b16 v[144:145], v248 offset:0
    ds_read_b64_tr_b16 v[146:147], v248 offset:1024
    ds_read_b64_tr_b16 v[148:149], v248 offset:8
    ds_read_b64_tr_b16 v[150:151], v248 offset:1032
    ds_read_b128 v[208:211], v244 offset:0
    ds_read_b128 v[212:215], v244 offset:2048
    ds_read_b128 v[216:219], v244 offset:4096
    ds_read_b128 v[220:223], v244 offset:6144
    v_mfma_f32_16x16x32_bf16 v[160:163], v[136:139], v[224:227], v[160:163]
    v_mfma_f32_16x16x32_bf16 v[164:167], v[140:143], v[224:227], v[164:167]
    v_mfma_f32_16x16x32_bf16 v[168:171], v[136:139], v[228:231], v[168:171]
    v_mfma_f32_16x16x32_bf16 v[172:175], v[140:143], v[228:231], v[172:175]
    v_mfma_f32_16x16x32_bf16 v[192:195], v[136:139], v[240:243], v[192:195]
    v_mfma_f32_16x16x32_bf16 v[176:179], v[136:139], v[232:235], v[176:179]
    v_mfma_f32_16x16x32_bf16 v[180:183], v[140:143], v[232:235], v[180:183]
    v_mfma_f32_16x16x32_bf16 v[184:187], v[136:139], v[236:239], v[184:187]
    v_mfma_f32_16x16x32_bf16 v[188:191], v[140:143], v[236:239], v[188:191]
    v_mfma_f32_16x16x32_bf16 v[196:199], v[140:143], v[240:243], v[196:199]
    ds_read_b64_tr_b16 v[152:153], v248 offset:8192
    ds_read_b64_tr_b16 v[154:155], v248 offset:9216
    ds_read_b64_tr_b16 v[156:157], v248 offset:8200
    ds_read_b64_tr_b16 v[158:159], v248 offset:9224
    ds_read_b128 v[224:227], v245 offset:0
    ds_read_b128 v[228:231], v245 offset:2048
    s_waitcnt lgkmcnt(8)
    v_mfma_f32_16x16x32_bf16 v[160:163], v[144:147], v[208:211], v[160:163]
    v_mfma_f32_16x16x32_bf16 v[164:167], v[148:151], v[208:211], v[164:167]
    v_mfma_f32_16x16x32_bf16 v[168:171], v[144:147], v[212:215], v[168:171]
    v_mfma_f32_16x16x32_bf16 v[172:175], v[148:151], v[212:215], v[172:175]
    v_mfma_f32_16x16x32_bf16 v[192:195], v[144:147], v[240:243], v[192:195]
    ds_read_b128 v[232:235], v245 offset:4096
    ds_read_b128 v[236:239], v245 offset:6144
    s_waitcnt lgkmcnt(8)
    v_mfma_f32_16x16x32_bf16 v[176:179], v[144:147], v[216:219], v[176:179]
    v_mfma_f32_16x16x32_bf16 v[180:183], v[148:151], v[216:219], v[180:183]
    v_mfma_f32_16x16x32_bf16 v[184:187], v[144:147], v[220:223], v[184:187]
    v_mfma_f32_16x16x32_bf16 v[188:191], v[148:151], v[220:223], v[188:191]
    v_mfma_f32_16x16x32_bf16 v[196:199], v[148:151], v[240:243], v[196:199]
    s_waitcnt lgkmcnt(0)
    v_lshlrev_b32 v254, 4, v255
    v_add_u32 v254, 155648, v254
    ds_read_b32 v246, v254 offset:8
    v_and_b32 v254, 15, v255
    v_lshlrev_b32 v254, 4, v254
    v_add_u32 v254, 155648, v254
    ds_read_b64 v[200:201], v254 offset:0
    ds_read_b64 v[202:203], v254 offset:256
    ds_read_b64 v[204:205], v254 offset:512
    ds_read_b64 v[206:207], v254 offset:768
    v_mfma_f32_16x16x32_bf16 v[160:163], v[152:155], v[224:227], v[160:163]
    v_mfma_f32_16x16x32_bf16 v[164:167], v[156:159], v[224:227], v[164:167]
    v_mfma_f32_16x16x32_bf16 v[168:171], v[152:155], v[228:231], v[168:171]
    v_mfma_f32_16x16x32_bf16 v[172:175], v[156:159], v[228:231], v[172:175]
    v_mfma_f32_16x16x32_bf16 v[192:195], v[152:155], v[240:243], v[192:195]
    v_mfma_f32_16x16x32_bf16 v[176:179], v[152:155], v[232:235], v[176:179]
    v_mfma_f32_16x16x32_bf16 v[180:183], v[156:159], v[232:235], v[180:183]
    v_mfma_f32_16x16x32_bf16 v[184:187], v[152:155], v[236:239], v[184:187]
    v_mfma_f32_16x16x32_bf16 v[188:191], v[156:159], v[236:239], v[188:191]
    v_mfma_f32_16x16x32_bf16 v[196:199], v[156:159], v[240:243], v[196:199]
    s_add_u32 s5, s58, 16384
    s_waitcnt lgkmcnt(0)
    v_cmp_ne_u32 vcc, s6, v246
    s_cbranch_vccnz Lln_25
Llnd_26:
    v_mul_f32 v200, s57, v200
    v_mul_f32 v202, s57, v202
    v_mul_f32 v204, s57, v204
    v_mul_f32 v206, s57, v206
    v_fma_f32 v160, -v201, v192, v160
    v_fma_f32 v161, -v201, v193, v161
    v_fma_f32 v162, -v201, v194, v162
    v_fma_f32 v163, -v201, v195, v163
    v_fma_f32 v164, -v201, v196, v164
    v_fma_f32 v165, -v201, v197, v165
    v_fma_f32 v166, -v201, v198, v166
    v_fma_f32 v167, -v201, v199, v167
    v_mul_f32 v160, v200, v160
    v_mul_f32 v161, v200, v161
    v_mul_f32 v162, v200, v162
    v_mul_f32 v163, v200, v163
    v_mul_f32 v164, v200, v164
    v_mul_f32 v165, v200, v165
    v_mul_f32 v166, v200, v166
    v_mul_f32 v167, v200, v167
    v_add_u32 v160, s56, v160
    s_barrier
    ds_read_b128 v[208:211], v244 offset:24576
    ds_read_b128 v[212:215], v244 offset:26624
    ds_read_b128 v[216:219], v245 offset:24576
    ds_read_b128 v[220:223], v245 offset:26624
    v_lshlrev_b32 v254, 4, v255
    v_add_u32 v254, 156672, v254
    ds_read_b32 v247, v254 offset:8
    v_and_b32 v254, 15, v255
    v_lshlrev_b32 v254, 4, v254
    v_add_u32 v254, 156672, v254
    ds_read_b64 v[250:251], v254 offset:0
    ds_read_b64 v[252:253], v254 offset:256
    ds_read_b64 v[240:241], v254 offset:512
    ds_read_b64 v[242:243], v254 offset:768
    s_waitcnt lgkmcnt(8)
    v_mfma_f32_16x16x32_bf16 v[224:227], v[0:3], v[208:211], 0
    v_add_u32 v164, s56, v164
    v_cvt_pk_bf16_f32 v160, v160, v161
    v_mfma_f32_16x16x32_bf16 v[228:231], v[4:7], v[208:211], 0
    v_cvt_pk_bf16_f32 v161, v162, v163
    v_cvt_pk_bf16_f32 v162, v164, v165
    s_waitcnt lgkmcnt(7)
    v_mfma_f32_16x16x32_bf16 v[232:235], v[0:3], v[212:215], 0
    v_cvt_pk_bf16_f32 v163, v166, v167
    v_and_b32 v160, s59, v160
    v_mfma_f32_16x16x32_bf16 v[236:239], v[4:7], v[212:215], 0
    ds_read_b128 v[208:211], v244 offset:32768
    v_and_b32 v162, s59, v162
    buffer_store_dwordx4 v[160:163], v249, s[40:43], s58 offen offset:0 sc1
    s_waitcnt lgkmcnt(7)
    v_mfma_f32_16x16x32_bf16 v[224:227], v[8:11], v[216:219], v[224:227]
    v_fma_f32 v168, -v203, v192, v168
    v_fma_f32 v169, -v203, v193, v169
    v_mfma_f32_16x16x32_bf16 v[228:231], v[12:15], v[216:219], v[228:231]
    ds_read_b128 v[212:215], v244 offset:34816
    ds_read_b128 v[160:163], v245 offset:32768
    v_fma_f32 v170, -v203, v194, v170
    v_fma_f32 v171, -v203, v195, v171
    s_waitcnt lgkmcnt(8)
    v_mfma_f32_16x16x32_bf16 v[232:235], v[8:11], v[220:223], v[232:235]
    v_fma_f32 v172, -v203, v196, v172
    v_fma_f32 v173, -v203, v197, v173
    v_mfma_f32_16x16x32_bf16 v[236:239], v[12:15], v[220:223], v[236:239]
    ds_read_b128 v[164:167], v245 offset:34816
    ds_read_b128 v[216:219], v244 offset:40960
    v_fma_f32 v174, -v203, v198, v174
    v_fma_f32 v175, -v203, v199, v175
    s_waitcnt lgkmcnt(4)
    v_mfma_f32_16x16x32_bf16 v[224:227], v[16:19], v[208:211], v[224:227]
    v_mul_f32 v168, v202, v168
    v_mul_f32 v169, v202, v169
    v_mfma_f32_16x16x32_bf16 v[228:231], v[20:23], v[208:211], v[228:231]
    ds_read_b128 v[220:223], v244 offset:43008
    v_mul_f32 v170, v202, v170
    v_mul_f32 v171, v202, v171
    s_waitcnt lgkmcnt(4)
    v_mfma_f32_16x16x32_bf16 v[232:235], v[16:19], v[212:215], v[232:235]
    v_mul_f32 v172, v202, v172
    v_mul_f32 v173, v202, v173
    v_mfma_f32_16x16x32_bf16 v[236:239], v[20:23], v[212:215], v[236:239]
    ds_read_b128 v[208:211], v245 offset:40960
    v_mul_f32 v174, v202, v174
    v_mul_f32 v175, v202, v175
    s_waitcnt lgkmcnt(4)
    v_mfma_f32_16x16x32_bf16 v[224:227], v[24:27], v[160:163], v[224:227]
    v_add_u32 v168, s56, v168
    v_add_u32 v172, s56, v172
    v_mfma_f32_16x16x32_bf16 v[228:231], v[28:31], v[160:163], v[228:231]
    ds_read_b128 v[212:215], v245 offset:43008
    v_cvt_pk_bf16_f32 v168, v168, v169
    v_cvt_pk_bf16_f32 v169, v170, v171
    s_waitcnt lgkmcnt(4)
    v_mfma_f32_16x16x32_bf16 v[232:235], v[24:27], v[164:167], v[232:235]
    v_cvt_pk_bf16_f32 v170, v172, v173
    v_cvt_pk_bf16_f32 v171, v174, v175
    v_mfma_f32_16x16x32_bf16 v[236:239], v[28:31], v[164:167], v[236:239]
    ds_read_b128 v[160:163], v244 offset:49152
    v_and_b32 v168, s59, v168
    v_and_b32 v170, s59, v170
    s_waitcnt lgkmcnt(4)
    v_mfma_f32_16x16x32_bf16 v[224:227], v[32:35], v[216:219], v[224:227]
    buffer_store_dwordx4 v[168:171], v249, s[40:43], s58 offen offset:256 sc1
    v_fma_f32 v176, -v205, v192, v176
    v_mfma_f32_16x16x32_bf16 v[228:231], v[36:39], v[216:219], v[228:231]
    ds_read_b128 v[164:167], v244 offset:51200
    ds_read_b128 v[168:171], v245 offset:49152
    v_fma_f32 v177, -v205, v193, v177
    v_fma_f32 v178, -v205, v194, v178
    s_waitcnt lgkmcnt(5)
    v_mfma_f32_16x16x32_bf16 v[232:235], v[32:35], v[220:223], v[232:235]
    v_fma_f32 v179, -v205, v195, v179
    v_fma_f32 v180, -v205, v196, v180
    v_mfma_f32_16x16x32_bf16 v[236:239], v[36:39], v[220:223], v[236:239]
    ds_read_b128 v[172:175], v245 offset:51200
    ds_read_b128 v[216:219], v244 offset:57344
    v_fma_f32 v181, -v205, v197, v181
    v_fma_f32 v182, -v205, v198, v182
    s_waitcnt lgkmcnt(6)
    v_mfma_f32_16x16x32_bf16 v[224:227], v[40:43], v[208:211], v[224:227]
    v_fma_f32 v183, -v205, v199, v183
    v_mul_f32 v176, v204, v176
    v_mfma_f32_16x16x32_bf16 v[228:231], v[44:47], v[208:211], v[228:231]
    ds_read_b128 v[220:223], v244 offset:59392
    v_mul_f32 v177, v204, v177
    v_mul_f32 v178, v204, v178
    s_waitcnt lgkmcnt(6)
    v_mfma_f32_16x16x32_bf16 v[232:235], v[40:43], v[212:215], v[232:235]
    v_mul_f32 v179, v204, v179
    v_mul_f32 v180, v204, v180
    v_mfma_f32_16x16x32_bf16 v[236:239], v[44:47], v[212:215], v[236:239]
    ds_read_b128 v[208:211], v245 offset:57344
    v_mul_f32 v181, v204, v181
    v_mul_f32 v182, v204, v182
    s_waitcnt lgkmcnt(6)
    v_mfma_f32_16x16x32_bf16 v[224:227], v[48:51], v[160:163], v[224:227]
    v_mul_f32 v183, v204, v183
    v_add_u32 v176, s56, v176
    v_mfma_f32_16x16x32_bf16 v[228:231], v[52:55], v[160:163], v[228:231]
    ds_read_b128 v[212:215], v245 offset:59392
    v_add_u32 v180, s56, v180
    v_cvt_pk_bf16_f32 v176, v176, v177
    s_waitcnt lgkmcnt(6)
    v_mfma_f32_16x16x32_bf16 v[232:235], v[48:51], v[164:167], v[232:235]
    v_cvt_pk_bf16_f32 v177, v178, v179
    v_cvt_pk_bf16_f32 v178, v180, v181
    v_mfma_f32_16x16x32_bf16 v[236:239], v[52:55], v[164:167], v[236:239]
    v_add_u32 v244, 40960, v244
    ds_read_b128 v[160:163], v244 offset:24576
    v_cvt_pk_bf16_f32 v179, v182, v183
    v_and_b32 v176, s59, v176
    s_waitcnt lgkmcnt(6)
    v_mfma_f32_16x16x32_bf16 v[224:227], v[56:59], v[168:171], v[224:227]
    v_and_b32 v178, s59, v178
    buffer_store_dwordx4 v[176:179], v249, s[40:43], s58 offen offset:512 sc1
    v_mfma_f32_16x16x32_bf16 v[228:231], v[60:63], v[168:171], v[228:231]
    ds_read_b128 v[164:167], v244 offset:26624
    v_fma_f32 v184, -v207, v192, v184
    v_fma_f32 v185, -v207, v193, v185
    s_waitcnt lgkmcnt(6)
    v_mfma_f32_16x16x32_bf16 v[232:235], v[56:59], v[172:175], v[232:235]
    v_fma_f32 v186, -v207, v194, v186
    v_fma_f32 v187, -v207, v195, v187
    v_mfma_f32_16x16x32_bf16 v[236:239], v[60:63], v[172:175], v[236:239]
    v_add_u32 v245, 40960, v245
    ds_read_b128 v[176:179], v245 offset:24576
    v_fma_f32 v188, -v207, v196, v188
    v_fma_f32 v189, -v207, v197, v189
    s_waitcnt lgkmcnt(6)
    v_mfma_f32_16x16x32_bf16 v[224:227], v[64:67], v[216:219], v[224:227]
    v_fma_f32 v190, -v207, v198, v190
    v_fma_f32 v191, -v207, v199, v191
    v_mfma_f32_16x16x32_bf16 v[228:231], v[68:71], v[216:219], v[228:231]
    ds_read_b128 v[180:183], v245 offset:26624
    v_mul_f32 v184, v206, v184
    v_mul_f32 v185, v206, v185
    s_waitcnt lgkmcnt(6)
    v_mfma_f32_16x16x32_bf16 v[232:235], v[64:67], v[220:223], v[232:235]
    v_mul_f32 v186, v206, v186
    v_mul_f32 v187, v206, v187
    v_mfma_f32_16x16x32_bf16 v[236:239], v[68:71], v[220:223], v[236:239]
    s_barrier
    ds_read_b128 v[168:171], v244 offset:32768
    v_mul_f32 v188, v206, v188
    v_mul_f32 v189, v206, v189
    s_waitcnt lgkmcnt(6)
    v_mfma_f32_16x16x32_bf16 v[224:227], v[72:75], v[208:211], v[224:227]
    v_mul_f32 v190, v206, v190
    v_mul_f32 v191, v206, v191
    v_mfma_f32_16x16x32_bf16 v[228:231], v[76:79], v[208:211], v[228:231]
    ds_read_b128 v[172:175], v244 offset:34816
    v_add_u32 v184, s56, v184
    v_add_u32 v188, s56, v188
    s_waitcnt lgkmcnt(6)
    v_mfma_f32_16x16x32_bf16 v[232:235], v[72:75], v[212:215], v[232:235]
    v_cvt_pk_bf16_f32 v184, v184, v185
    v_cvt_pk_bf16_f32 v185, v186, v187
    v_mfma_f32_16x16x32_bf16 v[236:239], v[76:79], v[212:215], v[236:239]
    ds_read_b128 v[216:219], v245 offset:32768
    v_cvt_pk_bf16_f32 v186, v188, v189
    v_cvt_pk_bf16_f32 v187, v190, v191
    s_waitcnt lgkmcnt(6)
    v_mfma_f32_16x16x32_bf16 v[224:227], v[80:83], v[160:163], v[224:227]
    v_and_b32 v184, s59, v184
    v_and_b32 v186, s59, v186
    v_mfma_f32_16x16x32_bf16 v[228:231], v[84:87], v[160:163], v[228:231]
    ds_read_b128 v[220:223], v245 offset:34816
    buffer_store_dwordx4 v[184:187], v249, s[40:43], s58 offen offset:768 sc1
    s_waitcnt lgkmcnt(6)
    v_mfma_f32_16x16x32_bf16 v[232:235], v[80:83], v[164:167], v[232:235]
    v_mfma_f32_16x16x32_bf16 v[236:239], v[84:87], v[164:167], v[236:239]
    ds_read_b128 v[208:211], v244 offset:40960
    s_waitcnt lgkmcnt(6)
    v_mfma_f32_16x16x32_bf16 v[224:227], v[88:91], v[176:179], v[224:227]
    v_mfma_f32_16x16x32_bf16 v[228:231], v[92:95], v[176:179], v[228:231]
    ds_read_b128 v[212:215], v244 offset:43008
    s_waitcnt lgkmcnt(6)
    v_mfma_f32_16x16x32_bf16 v[232:235], v[88:91], v[180:183], v[232:235]
    v_mfma_f32_16x16x32_bf16 v[236:239], v[92:95], v[180:183], v[236:239]
    ds_read_b128 v[184:187], v245 offset:40960
    s_waitcnt lgkmcnt(6)
    v_mfma_f32_16x16x32_bf16 v[224:227], v[96:99], v[168:171], v[224:227]
    v_mfma_f32_16x16x32_bf16 v[228:231], v[100:103], v[168:171], v[228:231]
    ds_read_b128 v[188:191], v245 offset:43008
    s_waitcnt lgkmcnt(6)
    v_mfma_f32_16x16x32_bf16 v[232:235], v[96:99], v[172:175], v[232:235]
    v_mfma_f32_16x16x32_bf16 v[236:239], v[100:103], v[172:175], v[236:239]
    ds_read_b128 v[176:179], v244 offset:49152
    s_waitcnt lgkmcnt(6)
    v_mfma_f32_16x16x32_bf16 v[224:227], v[104:107], v[216:219], v[224:227]
    v_mfma_f32_16x16x32_bf16 v[228:231], v[108:111], v[216:219], v[228:231]
    ds_read_b128 v[180:183], v244 offset:51200
    s_waitcnt lgkmcnt(6)
    v_mfma_f32_16x16x32_bf16 v[232:235], v[104:107], v[220:223], v[232:235]
    v_mfma_f32_16x16x32_bf16 v[236:239], v[108:111], v[220:223], v[236:239]
    ds_read_b128 v[216:219], v245 offset:49152
    s_waitcnt lgkmcnt(6)
    v_mfma_f32_16x16x32_bf16 v[224:227], v[112:115], v[208:211], v[224:227]
    v_mfma_f32_16x16x32_bf16 v[228:231], v[116:119], v[208:211], v[228:231]
    ds_read_b128 v[220:223], v245 offset:51200
    s_waitcnt lgkmcnt(6)
    v_mfma_f32_16x16x32_bf16 v[232:235], v[112:115], v[212:215], v[232:235]
    v_mfma_f32_16x16x32_bf16 v[236:239], v[116:119], v[212:215], v[236:239]
    ds_read_b128 v[208:211], v244 offset:57344
    s_waitcnt lgkmcnt(6)
    v_mfma_f32_16x16x32_bf16 v[224:227], v[120:123], v[184:187], v[224:227]
    v_mfma_f32_16x16x32_bf16 v[228:231], v[124:127], v[184:187], v[228:231]
    ds_read_b128 v[212:215], v244 offset:59392
    s_waitcnt lgkmcnt(6)
    v_cmp_ne_u32 vcc, s6, v247
    s_cbranch_vccnz Lln_27
Llnd_28:
    v_mfma_f32_16x16x32_bf16 v[232:235], v[120:123], v[188:191], v[232:235]
    v_mul_f32 v250, s57, v250
    v_mul_f32 v252, s57, v252
    v_mfma_f32_16x16x32_bf16 v[236:239], v[124:127], v[188:191], v[236:239]
    ds_read_b128 v[184:187], v245 offset:57344
    v_mul_f32 v240, s57, v240
    v_mul_f32 v242, s57, v242
    s_waitcnt lgkmcnt(6)
    v_mfma_f32_16x16x32_bf16 v[224:227], v[128:131], v[176:179], v[224:227]
    v_mul_f32 v160, -v241, v192
    v_mul_f32 v161, -v241, v193
    v_mfma_f32_16x16x32_bf16 v[228:231], v[132:135], v[176:179], v[228:231]
    ds_read_b128 v[188:191], v245 offset:59392
    v_mul_f32 v162, -v241, v194
    v_mul_f32 v163, -v241, v195
    s_waitcnt lgkmcnt(6)
    v_mfma_f32_16x16x32_bf16 v[232:235], v[128:131], v[180:183], v[232:235]
    v_mul_f32 v164, -v241, v196
    v_mul_f32 v165, -v241, v197
    v_mfma_f32_16x16x32_bf16 v[236:239], v[132:135], v[180:183], v[236:239]
    s_barrier
    v_subrev_u32 v244, 40960, v244
    ds_read_b128 v[176:179], v244 offset:28672
    v_mul_f32 v166, -v241, v198
    v_mul_f32 v167, -v241, v199
    s_waitcnt lgkmcnt(6)
    v_mfma_f32_16x16x32_bf16 v[224:227], v[136:139], v[216:219], v[224:227]
    v_mul_f32 v168, -v243, v192
    v_mul_f32 v169, -v243, v193
    v_mfma_f32_16x16x32_bf16 v[228:231], v[140:143], v[216:219], v[228:231]
    ds_read_b128 v[180:183], v244 offset:30720
    v_mul_f32 v170, -v243, v194
    v_mul_f32 v171, -v243, v195
    s_waitcnt lgkmcnt(6)
    v_mfma_f32_16x16x32_bf16 v[232:235], v[136:139], v[220:223], v[232:235]
    v_mul_f32 v172, -v243, v196
    v_mul_f32 v173, -v243, v197
    v_mfma_f32_16x16x32_bf16 v[236:239], v[140:143], v[220:223], v[236:239]
    v_subrev_u32 v245, 40960, v245
    ds_read_b128 v[216:219], v245 offset:28672
    v_mul_f32 v174, -v243, v198
    v_mul_f32 v175, -v243, v199
    s_waitcnt lgkmcnt(6)
    v_mfma_f32_16x16x32_bf16 v[224:227], v[144:147], v[208:211], v[224:227]
    v_mfma_f32_16x16x32_bf16 v[228:231], v[148:151], v[208:211], v[228:231]
    ds_read_b128 v[220:223], v245 offset:30720
    s_waitcnt lgkmcnt(6)
    v_mfma_f32_16x16x32_bf16 v[232:235], v[144:147], v[212:215], v[232:235]
    v_mfma_f32_16x16x32_bf16 v[236:239], v[148:151], v[212:215], v[236:239]
    ds_read_b128 v[208:211], v244 offset:36864
    s_waitcnt lgkmcnt(6)
    v_mfma_f32_16x16x32_bf16 v[224:227], v[152:155], v[184:187], v[224:227]
    v_mfma_f32_16x16x32_bf16 v[228:231], v[156:159], v[184:187], v[228:231]
    ds_read_b128 v[212:215], v244 offset:38912
    s_waitcnt lgkmcnt(6)
    v_mfma_f32_16x16x32_bf16 v[232:235], v[152:155], v[188:191], v[232:235]
    v_mfma_f32_16x16x32_bf16 v[236:239], v[156:159], v[188:191], v[236:239]
    ds_read_b128 v[184:187], v245 offset:36864
    s_waitcnt lgkmcnt(6)
    v_mfma_f32_16x16x32_bf16 v[160:163], v[0:3], v[176:179], v[160:163]
    v_mfma_f32_16x16x32_bf16 v[164:167], v[4:7], v[176:179], v[164:167]
    ds_read_b128 v[188:191], v245 offset:38912
    s_waitcnt lgkmcnt(6)
    v_mfma_f32_16x16x32_bf16 v[168:171], v[0:3], v[180:183], v[168:171]
    v_mfma_f32_16x16x32_bf16 v[172:175], v[4:7], v[180:183], v[172:175]
    ds_read_b128 v[176:179], v244 offset:45056
    s_waitcnt lgkmcnt(6)
    v_mfma_f32_16x16x32_bf16 v[160:163], v[8:11], v[216:219], v[160:163]
    v_mfma_f32_16x16x32_bf16 v[164:167], v[12:15], v[216:219], v[164:167]
    ds_read_b128 v[180:183], v244 offset:47104
    s_waitcnt lgkmcnt(6)
    v_mfma_f32_16x16x32_bf16 v[168:171], v[8:11], v[220:223], v[168:171]
    v_mfma_f32_16x16x32_bf16 v[172:175], v[12:15], v[220:223], v[172:175]
    ds_read_b128 v[0:3], v245 offset:45056
    s_waitcnt lgkmcnt(6)
    v_mfma_f32_16x16x32_bf16 v[160:163], v[16:19], v[208:211], v[160:163]
    v_fma_f32 v224, -v251, v192, v224
    v_mfma_f32_16x16x32_bf16 v[164:167], v[20:23], v[208:211], v[164:167]
    ds_read_b128 v[4:7], v245 offset:47104
    v_fma_f32 v225, -v251, v193, v225
    s_waitcnt lgkmcnt(6)
    v_mfma_f32_16x16x32_bf16 v[168:171], v[16:19], v[212:215], v[168:171]
    v_fma_f32 v226, -v251, v194, v226
    v_mfma_f32_16x16x32_bf16 v[172:175], v[20:23], v[212:215], v[172:175]
    ds_read_b128 v[216:219], v244 offset:53248
    v_fma_f32 v227, -v251, v195, v227
    s_waitcnt lgkmcnt(6)
    v_mfma_f32_16x16x32_bf16 v[160:163], v[24:27], v[184:187], v[160:163]
    v_fma_f32 v228, -v251, v196, v228
    v_mfma_f32_16x16x32_bf16 v[164:167], v[28:31], v[184:187], v[164:167]
    ds_read_b128 v[220:223], v244 offset:55296
    v_fma_f32 v229, -v251, v197, v229
    s_waitcnt vmcnt(0)
    v_mov_b32 v254, s6
    s_mov_b64 exec, 1
    buffer_store_dword v254, off, s[40:43], s67 sc1
    s_mov_b64 exec, -1
    s_waitcnt lgkmcnt(6)
    v_mfma_f32_16x16x32_bf16 v[168:171], v[24:27], v[188:191], v[168:171]
    v_fma_f32 v230, -v251, v198, v230
    v_mfma_f32_16x16x32_bf16 v[172:175], v[28:31], v[188:191], v[172:175]
    ds_read_b128 v[8:11], v245 offset:53248
    v_fma_f32 v231, -v251, v199, v231
    s_waitcnt lgkmcnt(6)
    v_mfma_f32_16x16x32_bf16 v[160:163], v[32:35], v[176:179], v[160:163]
    v_mul_f32 v224, v250, v224
    v_mfma_f32_16x16x32_bf16 v[164:167], v[36:39], v[176:179], v[164:167]
    ds_read_b128 v[12:15], v245 offset:55296
    v_mul_f32 v225, v250, v225
    s_waitcnt lgkmcnt(6)
    v_mfma_f32_16x16x32_bf16 v[168:171], v[32:35], v[180:183], v[168:171]
    v_mul_f32 v226, v250, v226
    v_mfma_f32_16x16x32_bf16 v[172:175], v[36:39], v[180:183], v[172:175]
    ds_read_b128 v[208:211], v244 offset:61440
    v_mul_f32 v227, v250, v227
    s_waitcnt lgkmcnt(6)
    v_mfma_f32_16x16x32_bf16 v[160:163], v[40:43], v[0:3], v[160:163]
    v_mul_f32 v228, v250, v228
    v_mfma_f32_16x16x32_bf16 v[164:167], v[44:47], v[0:3], v[164:167]
    ds_read_b128 v[212:215], v244 offset:63488
    v_mul_f32 v229, v250, v229
    s_waitcnt lgkmcnt(6)
    v_mfma_f32_16x16x32_bf16 v[168:171], v[40:43], v[4:7], v[168:171]
    v_mul_f32 v230, v250, v230
    v_mfma_f32_16x16x32_bf16 v[172:175], v[44:47], v[4:7], v[172:175]
    ds_read_b128 v[16:19], v245 offset:61440
    v_mul_f32 v231, v250, v231
    s_waitcnt lgkmcnt(6)
    v_mfma_f32_16x16x32_bf16 v[160:163], v[48:51], v[216:219], v[160:163]
    v_add_u32 v224, s56, v224
    v_mfma_f32_16x16x32_bf16 v[164:167], v[52:55], v[216:219], v[164:167]
    ds_read_b128 v[20:23], v245 offset:63488
    v_add_u32 v228, s56, v228
    s_waitcnt lgkmcnt(6)
    v_mfma_f32_16x16x32_bf16 v[168:171], v[48:51], v[220:223], v[168:171]
    v_cvt_pk_bf16_f32 v224, v224, v225
    v_mfma_f32_16x16x32_bf16 v[172:175], v[52:55], v[220:223], v[172:175]
    v_add_u32 v244, 40960, v244
    ds_read_b128 v[184:187], v244 offset:28672
    v_cvt_pk_bf16_f32 v225, v226, v227
    s_waitcnt lgkmcnt(6)
    v_mfma_f32_16x16x32_bf16 v[160:163], v[56:59], v[8:11], v[160:163]
    v_cvt_pk_bf16_f32 v226, v228, v229
    v_mfma_f32_16x16x32_bf16 v[164:167], v[60:63], v[8:11], v[164:167]
    ds_read_b128 v[188:191], v244 offset:30720
    v_cvt_pk_bf16_f32 v227, v230, v231
    s_waitcnt lgkmcnt(6)
    v_mfma_f32_16x16x32_bf16 v[168:171], v[56:59], v[12:15], v[168:171]
    v_and_b32 v224, s59, v224
    v_mfma_f32_16x16x32_bf16 v[172:175], v[60:63], v[12:15], v[172:175]
    v_add_u32 v245, 40960, v245
    ds_read_b128 v[24:27], v245 offset:28672
    v_and_b32 v226, s59, v226
    s_waitcnt lgkmcnt(6)
    v_mfma_f32_16x16x32_bf16 v[160:163], v[64:67], v[208:211], v[160:163]
    buffer_store_dwordx4 v[224:227], v249, s[40:43], s5 offen offset:0 sc1
    v_mfma_f32_16x16x32_bf16 v[164:167], v[68:71], v[208:211], v[164:167]
    ds_read_b128 v[28:31], v245 offset:30720
    v_fma_f32 v232, -v253, v192, v232
    s_waitcnt lgkmcnt(6)
    v_mfma_f32_16x16x32_bf16 v[168:171], v[64:67], v[212:215], v[168:171]
    v_fma_f32 v233, -v253, v193, v233
    v_mfma_f32_16x16x32_bf16 v[172:175], v[68:71], v[212:215], v[172:175]
    ds_read_b128 v[176:179], v244 offset:36864
    v_fma_f32 v234, -v253, v194, v234
    s_waitcnt lgkmcnt(6)
    v_mfma_f32_16x16x32_bf16 v[160:163], v[72:75], v[16:19], v[160:163]
    v_fma_f32 v235, -v253, v195, v235
    v_mfma_f32_16x16x32_bf16 v[164:167], v[76:79], v[16:19], v[164:167]
    ds_read_b128 v[180:183], v244 offset:38912
    v_fma_f32 v236, -v253, v196, v236
    s_waitcnt lgkmcnt(6)
    v_mfma_f32_16x16x32_bf16 v[168:171], v[72:75], v[20:23], v[168:171]
    v_fma_f32 v237, -v253, v197, v237
    v_mfma_f32_16x16x32_bf16 v[172:175], v[76:79], v[20:23], v[172:175]
    ds_read_b128 v[32:35], v245 offset:36864
    v_fma_f32 v238, -v253, v198, v238
    s_waitcnt lgkmcnt(6)
    v_mfma_f32_16x16x32_bf16 v[160:163], v[80:83], v[184:187], v[160:163]
    v_fma_f32 v239, -v253, v199, v239
    v_mfma_f32_16x16x32_bf16 v[164:167], v[84:87], v[184:187], v[164:167]
    ds_read_b128 v[36:39], v245 offset:38912
    v_mul_f32 v232, v252, v232
    s_waitcnt lgkmcnt(6)
    v_mfma_f32_16x16x32_bf16 v[168:171], v[80:83], v[188:191], v[168:171]
    v_mul_f32 v233, v252, v233
    v_mfma_f32_16x16x32_bf16 v[172:175], v[84:87], v[188:191], v[172:175]
    ds_read_b128 v[0:3], v244 offset:45056
    v_mul_f32 v234, v252, v234
    s_waitcnt lgkmcnt(6)
    v_mfma_f32_16x16x32_bf16 v[160:163], v[88:91], v[24:27], v[160:163]
    v_mul_f32 v235, v252, v235
    v_mfma_f32_16x16x32_bf16 v[164:167], v[92:95], v[24:27], v[164:167]
    ds_read_b128 v[4:7], v244 offset:47104
    v_mul_f32 v236, v252, v236
    s_waitcnt lgkmcnt(6)
    v_mfma_f32_16x16x32_bf16 v[168:171], v[88:91], v[28:31], v[168:171]
    v_mul_f32 v237, v252, v237
    v_mfma_f32_16x16x32_bf16 v[172:175], v[92:95], v[28:31], v[172:175]
    ds_read_b128 v[40:43], v245 offset:45056
    v_mul_f32 v238, v252, v238
    s_waitcnt lgkmcnt(6)
    v_mfma_f32_16x16x32_bf16 v[160:163], v[96:99], v[176:179], v[160:163]
    v_mul_f32 v239, v252, v239
    v_mfma_f32_16x16x32_bf16 v[164:167], v[100:103], v[176:179], v[164:167]
    ds_read_b128 v[44:47], v245 offset:47104
    v_add_u32 v232, s56, v232
    s_waitcnt lgkmcnt(6)
    v_mfma_f32_16x16x32_bf16 v[168:171], v[96:99], v[180:183], v[168:171]
    v_add_u32 v236, s56, v236
    v_mfma_f32_16x16x32_bf16 v[172:175], v[100:103], v[180:183], v[172:175]
    ds_read_b128 v[216:219], v244 offset:53248
    v_cvt_pk_bf16_f32 v232, v232, v233
    s_waitcnt lgkmcnt(6)
    v_mfma_f32_16x16x32_bf16 v[160:163], v[104:107], v[32:35], v[160:163]
    v_cvt_pk_bf16_f32 v233, v234, v235
    v_mfma_f32_16x16x32_bf16 v[164:167], v[108:111], v[32:35], v[164:167]
    ds_read_b128 v[220:223], v244 offset:55296
    v_cvt_pk_bf16_f32 v234, v236, v237
    s_waitcnt lgkmcnt(6)
    v_mfma_f32_16x16x32_bf16 v[168:171], v[104:107], v[36:39], v[168:171]
    v_cvt_pk_bf16_f32 v235, v238, v239
    v_mfma_f32_16x16x32_bf16 v[172:175], v[108:111], v[36:39], v[172:175]
    ds_read_b128 v[48:51], v245 offset:53248
    v_and_b32 v232, s59, v232
    s_waitcnt lgkmcnt(6)
    v_mfma_f32_16x16x32_bf16 v[160:163], v[112:115], v[0:3], v[160:163]
    v_and_b32 v234, s59, v234
    v_mfma_f32_16x16x32_bf16 v[164:167], v[116:119], v[0:3], v[164:167]
    ds_read_b128 v[52:55], v245 offset:55296
    buffer_store_dwordx4 v[232:235], v249, s[40:43], s5 offen offset:256 sc1
    s_waitcnt lgkmcnt(6)
    v_mfma_f32_16x16x32_bf16 v[168:171], v[112:115], v[4:7], v[168:171]
    v_mfma_f32_16x16x32_bf16 v[172:175], v[116:119], v[4:7], v[172:175]
    ds_read_b128 v[8:11], v244 offset:61440
    s_waitcnt lgkmcnt(6)
    v_mfma_f32_16x16x32_bf16 v[160:163], v[120:123], v[40:43], v[160:163]
    v_mfma_f32_16x16x32_bf16 v[164:167], v[124:127], v[40:43], v[164:167]
    ds_read_b128 v[12:15], v244 offset:63488
    s_waitcnt lgkmcnt(6)
    v_mfma_f32_16x16x32_bf16 v[168:171], v[120:123], v[44:47], v[168:171]
    v_mfma_f32_16x16x32_bf16 v[172:175], v[124:127], v[44:47], v[172:175]
    ds_read_b128 v[56:59], v245 offset:61440
    s_waitcnt lgkmcnt(6)
    v_mfma_f32_16x16x32_bf16 v[160:163], v[128:131], v[216:219], v[160:163]
    v_mfma_f32_16x16x32_bf16 v[164:167], v[132:135], v[216:219], v[164:167]
    ds_read_b128 v[60:63], v245 offset:63488
    s_waitcnt lgkmcnt(6)
    v_mfma_f32_16x16x32_bf16 v[168:171], v[128:131], v[220:223], v[168:171]
    v_mfma_f32_16x16x32_bf16 v[172:175], v[132:135], v[220:223], v[172:175]
    s_waitcnt lgkmcnt(5)
    v_mfma_f32_16x16x32_bf16 v[160:163], v[136:139], v[48:51], v[160:163]
    v_mfma_f32_16x16x32_bf16 v[164:167], v[140:143], v[48:51], v[164:167]
    s_waitcnt lgkmcnt(4)
    v_mfma_f32_16x16x32_bf16 v[168:171], v[136:139], v[52:55], v[168:171]
    v_mfma_f32_16x16x32_bf16 v[172:175], v[140:143], v[52:55], v[172:175]
    s_waitcnt lgkmcnt(3)
    v_mfma_f32_16x16x32_bf16 v[160:163], v[144:147], v[8:11], v[160:163]
    v_mfma_f32_16x16x32_bf16 v[164:167], v[148:151], v[8:11], v[164:167]
    s_waitcnt lgkmcnt(2)
    v_mfma_f32_16x16x32_bf16 v[168:171], v[144:147], v[12:15], v[168:171]
    v_mfma_f32_16x16x32_bf16 v[172:175], v[148:151], v[12:15], v[172:175]
    s_waitcnt lgkmcnt(1)
    v_mfma_f32_16x16x32_bf16 v[160:163], v[152:155], v[56:59], v[160:163]
    v_mfma_f32_16x16x32_bf16 v[164:167], v[156:159], v[56:59], v[164:167]
    s_waitcnt lgkmcnt(0)
    v_mfma_f32_16x16x32_bf16 v[168:171], v[152:155], v[60:63], v[168:171]
    v_mfma_f32_16x16x32_bf16 v[172:175], v[156:159], v[60:63], v[172:175]
    v_mov_b32 v246, 160768
    v_mov_b32 v247, 1
    s_mov_b64 exec, 1
    ds_add_u32 v246, v247
    s_mov_b64 exec, -1
    v_pk_mul_f32 v[160:161], v[160:161], v[240:241] op_sel_hi:[1,0]
    v_pk_mul_f32 v[162:163], v[162:163], v[240:241] op_sel_hi:[1,0]
    v_pk_mul_f32 v[164:165], v[164:165], v[240:241] op_sel_hi:[1,0]
    v_pk_mul_f32 v[166:167], v[166:167], v[240:241] op_sel_hi:[1,0]
    v_add_u32 v160, s56, v160
    v_add_u32 v164, s56, v164
    v_cvt_pk_bf16_f32 v160, v160, v161
    v_cvt_pk_bf16_f32 v161, v162, v163
    v_cvt_pk_bf16_f32 v162, v164, v165
    v_cvt_pk_bf16_f32 v163, v166, v167
    v_and_b32 v160, s59, v160
    v_and_b32 v162, s59, v162
    buffer_store_dwordx4 v[160:163], v249, s[40:43], s5 offen offset:512 sc1
    v_pk_mul_f32 v[168:169], v[168:169], v[242:243] op_sel_hi:[1,0]
    v_pk_mul_f32 v[170:171], v[170:171], v[242:243] op_sel_hi:[1,0]
    v_pk_mul_f32 v[172:173], v[172:173], v[242:243] op_sel_hi:[1,0]
    v_pk_mul_f32 v[174:175], v[174:175], v[242:243] op_sel_hi:[1,0]
    v_add_u32 v168, s56, v168
    v_add_u32 v172, s56, v172
    v_cvt_pk_bf16_f32 v168, v168, v169
    v_cvt_pk_bf16_f32 v169, v170, v171
    v_cvt_pk_bf16_f32 v170, v172, v173
    v_cvt_pk_bf16_f32 v171, v174, v175
    v_and_b32 v168, s59, v168
    v_and_b32 v170, s59, v170
    buffer_store_dwordx4 v[168:171], v249, s[40:43], s5 offen offset:768 sc1
    s_add_u32 s67, s67, 131072
    s_add_u32 s68, s49, 8
    s_and_b32 s73, s48, 1
    s_lshr_b32 s69, s48, 1
    s_mul_i32 s69, s69, 5
    s_add_u32 s71, s69, 2
    s_mul_i32 s3, s73, 3
    s_add_u32 s70, s69, s3
    s_lshl1_add_u32 s69, s73, s69
    s_lshl_b32 s72, s68, 1
    s_sub_u32 s72, s72, 4
    s_lshl2_add_u32 s55, s68, s52
    s_lshl_b32 s3, s55, 9
    s_add_u32 s3, s3, 16777216
    s_mul_i32 s57, s70, 32768
    s_add_u32 s57, s57, s3
    s_mul_i32 s58, s71, 32768
    s_add_u32 s58, s58, s3
    s_lshl3_add_u32 s58, s73, s58
    s_add_u32 s55, s55, 1
    s_mov_b32 s54, 0
    s_lshr_b32 s3, s52, 1
    s_add_u32 s3, s3, 4
    s_sub_u32 s3, s3, s52
    v_bfe_u32 v1, v255, 2, 1
    v_mul_u32_u24 v1, s3, v1
    s_add_u32 s3, s72, s52
    v_add_u32 v1, s3, v1
    v_max_i32 v1, 0, v1
    s_and_b32 s3, s52, 1
    s_lshl_b32 s3, s3, 4
    s_add_u32 s3, s3, 0x19
    v_and_b32 v2, 6, v255
    v_lshrrev_b32 v3, v2, s3
    v_and_b32 v3, 3, v3
    v_mul_u32_u24 v3, 80, v3
    v_and_b32 v2, 1, v255
    v_lshl_add_u32 v3, v2, 1, v3
    v_add_u32 v3, s69, v3
    v_lshrrev_b32 v3, 2, v3
    v_lshl_add_u32 v1, v1, 6, v3
    v_lshlrev_b32 v157, 7, v1
    v_lshrrev_b32 v1, 5, v255
    v_and_b32 v2, 31, v255
    s_lshl_b32 s3, s52, 9
    s_add_u32 s3, s3, 37376
    v_lshl_add_u32 v153, v2, 4, s3
    v_mul_u32_u24 v3, 6208, v1
    v_add_u32 v152, v153, v3
    v_add_u32 v153, 12416, v153
    v_lshl_add_u32 v153, s73, 3, v153
    v_lshlrev_b32 v3, 2, v1
    v_sub_u32 v7, v2, v3
    v_bfe_u32 v4, v255, 2, 2
    v_add_u32 v3, v3, v4
    v_lshlrev_b32 v3, 4, v3
    v_and_b32 v4, 1, v255
    v_mul_u32_u24 v4, 6208, v4
    v_bfe_u32 v5, v255, 1, 1
    v_lshl_add_u32 v4, v5, 3, v4
    s_lshl_b32 s74, s73, 3
    s_add_u32 s74, s74, 12416
    v_mov_b32 v5, s74
    v_and_b32 v6, 16, v255
    v_cmp_ne_u32 vcc, 0, v6
    s_nop 1
    v_cndmask_b32 v4, v4, v5, vcc
    s_add_u32 s3, s3, 22720
    v_add3_u32 v4, v4, v3, s3
    v_add_u32 v5, 161920, v3
    v_and_b32 v6, 19, v255
    v_cmp_lt_u32 vcc, 16, v6
    s_nop 1
    v_cndmask_b32 v156, v4, v5, vcc
    v_mov_b32 v4, 512
    v_cndmask_b32 v155, v4, 0, vcc
    v_lshlrev_b32 v104, 4, v2
    v_mul_u32_u24 v158, 32768, v1
    v_add_u32 v158, v158, v104
    v_lshlrev_b32 v159, 4, v2
    v_lshlrev_b32 v105, 4, v255
    s_waitcnt vmcnt(0)
    v_mov_b32 v8, s6
    s_mov_b64 exec, 1
    buffer_store_dword v8, off, s[40:43], s67 sc1
    s_mov_b64 exec, -1
    v_mov_b32 v4, 0xff800000
    s_cmp_lt_u32 s55, 9
    s_cselect_b32 s3, 0, -1
    v_mov_b32 v5, 0xffff
    v_subrev_u32 v64, 0, v7
    v_ashrrev_i32 v64, 31, v64
    v_mov_b32 v48, 0
    v_subrev_u32 v65, 1, v7
    v_ashrrev_i32 v65, 31, v65
    v_mov_b32 v49, 0
    v_subrev_u32 v66, 2, v7
    v_ashrrev_i32 v66, 31, v66
    v_mov_b32 v50, 0
    v_subrev_u32 v67, 3, v7
    v_ashrrev_i32 v67, 31, v67
    v_mov_b32 v51, 0
    v_subrev_u32 v68, 8, v7
    v_ashrrev_i32 v68, 31, v68
    v_mov_b32 v52, 0
    v_subrev_u32 v69, 9, v7
    v_ashrrev_i32 v69, 31, v69
    v_mov_b32 v53, 0
    v_subrev_u32 v70, 10, v7
    v_ashrrev_i32 v70, 31, v70
    v_mov_b32 v54, 0
    v_subrev_u32 v71, 11, v7
    v_ashrrev_i32 v71, 31, v71
    v_mov_b32 v55, 0
    v_subrev_u32 v72, 16, v7
    v_ashrrev_i32 v72, 31, v72
    v_mov_b32 v56, 0
    v_subrev_u32 v73, 17, v7
    v_ashrrev_i32 v73, 31, v73
    v_mov_b32 v57, 0
    v_subrev_u32 v74, 18, v7
    v_ashrrev_i32 v74, 31, v74
    v_mov_b32 v58, 0
    v_subrev_u32 v75, 19, v7
    v_ashrrev_i32 v75, 31, v75
    v_mov_b32 v59, 0
    v_subrev_u32 v76, 24, v7
    v_ashrrev_i32 v76, 31, v76
    v_mov_b32 v60, 0
    v_subrev_u32 v77, 25, v7
    v_ashrrev_i32 v77, 31, v77
    v_mov_b32 v61, 0
    v_subrev_u32 v78, 26, v7
    v_ashrrev_i32 v78, 31, v78
    v_mov_b32 v62, 0
    v_subrev_u32 v79, 27, v7
    v_ashrrev_i32 v79, 31, v79
    v_mov_b32 v63, 0
    v_bitop3_b32 v88, v5, v64, v65 bitop3:0xca
    v_not_b32 v80, v88
    v_and_b32 v88, s3, v88
    v_bitop3_b32 v89, v5, v66, v67 bitop3:0xca
    v_not_b32 v81, v89
    v_and_b32 v89, s3, v89
    v_bitop3_b32 v90, v5, v68, v69 bitop3:0xca
    v_not_b32 v82, v90
    v_and_b32 v90, s3, v90
    v_bitop3_b32 v91, v5, v70, v71 bitop3:0xca
    v_not_b32 v83, v91
    v_and_b32 v91, s3, v91
    v_bitop3_b32 v92, v5, v72, v73 bitop3:0xca
    v_not_b32 v84, v92
    v_and_b32 v92, s3, v92
    v_bitop3_b32 v93, v5, v74, v75 bitop3:0xca
    v_not_b32 v85, v93
    v_and_b32 v93, s3, v93
    v_bitop3_b32 v94, v5, v76, v77 bitop3:0xca
    v_not_b32 v86, v94
    v_and_b32 v94, s3, v94
    v_bitop3_b32 v95, v5, v78, v79 bitop3:0xca
    v_not_b32 v87, v95
    v_and_b32 v95, s3, v95
    s_branch LX_afterA
Lln_25:
    s_lshl_b32 s68, s46, 10
    s_add_u32 s68, s68, 688128
    v_lshlrev_b32 v254, 4, v255
    s_mov_b32 s83, 0
Lpoll_29:
    buffer_load_dwordx4 v[200:203], v254, s[40:43], s68 offen sc1
    s_add_u32 s83, s83, 1
    s_waitcnt vmcnt(0)
    v_cmp_ne_u32 vcc, s6, v202
    s_cbranch_vccz Lpd_30
    s_cmp_lt_u32 s83, 200000
    s_cbranch_scc1 Lpoll_29
Lpd_30:
    v_add_u32 v254, 155648, v254
    ds_write_b128 v254, v[200:203]
    v_lshlrev_b32 v254, 4, v255
    v_add_u32 v254, 155648, v254
    ds_read_b32 v246, v254 offset:8
    v_and_b32 v254, 15, v255
    v_lshlrev_b32 v254, 4, v254
    v_add_u32 v254, 155648, v254
    ds_read_b64 v[200:201], v254 offset:0
    ds_read_b64 v[202:203], v254 offset:256
    ds_read_b64 v[204:205], v254 offset:512
    ds_read_b64 v[206:207], v254 offset:768
    s_waitcnt lgkmcnt(0)
    s_branch Llnd_26
Lln_27:
    s_lshl_b32 s68, s46, 10
    s_add_u32 s68, s68, 704512
    v_lshlrev_b32 v254, 4, v255
    s_mov_b32 s83, 0
Lpoll_31:
    buffer_load_dwordx4 v[250:253], v254, s[40:43], s68 offen sc1
    s_add_u32 s83, s83, 1
    s_waitcnt vmcnt(0)
    v_cmp_ne_u32 vcc, s6, v252
    s_cbranch_vccz Lpd_32
    s_cmp_lt_u32 s83, 200000
    s_cbranch_scc1 Lpoll_31
Lpd_32:
    v_add_u32 v254, 156672, v254
    ds_write_b128 v254, v[250:253]
    v_lshlrev_b32 v254, 4, v255
    v_add_u32 v254, 156672, v254
    ds_read_b32 v247, v254 offset:8
    v_and_b32 v254, 15, v255
    v_lshlrev_b32 v254, 4, v254
    v_add_u32 v254, 156672, v254
    ds_read_b64 v[250:251], v254 offset:0
    ds_read_b64 v[252:253], v254 offset:256
    ds_read_b64 v[240:241], v254 offset:512
    ds_read_b64 v[242:243], v254 offset:768
    s_waitcnt lgkmcnt(0)
    s_branch Llnd_28
LX_skipA:
    s_waitcnt vmcnt(0)
    s_barrier
    v_mov_b32 v208, 160768
    v_mov_b32 v209, 1
    s_mov_b64 exec, 1
    ds_add_u32 v208, v209
    s_mov_b64 exec, -1
    v_lshlrev_b32 v1, 7, v255
    s_and_b32 s68, s45, 1
    s_lshl2_add_u32 s68, s68, s52
    s_mul_i32 s3, s44, 12
    s_add_u32 s68, s68, s3
    s_mov_b32 s69, 0
LX_pf:
    s_lshl_b32 s3, s68, 13
    buffer_load_dword v2, v1, s[16:19], s3 offen
    s_add_u32 s68, s68, 8
    s_sub_u32 s3, s68, 104
    s_cmp_ge_u32 s68, 104
    s_cselect_b32 s68, s3, s68
    s_add_u32 s69, s69, 1
    s_cmp_lt_u32 s69, 13
    s_cbranch_scc1 LX_pf
    s_waitcnt vmcnt(0)
    s_add_u32 s68, s49, 8
    s_and_b32 s73, s48, 1
    s_lshr_b32 s69, s48, 1
    s_mul_i32 s69, s69, 5
    s_add_u32 s71, s69, 2
    s_mul_i32 s3, s73, 3
    s_add_u32 s70, s69, s3
    s_lshl1_add_u32 s69, s73, s69
    s_lshl_b32 s72, s68, 1
    s_sub_u32 s72, s72, 4
    s_lshl2_add_u32 s55, s68, s52
    s_lshl_b32 s3, s55, 9
    s_add_u32 s3, s3, 16777216
    s_mul_i32 s57, s70, 32768
    s_add_u32 s57, s57, s3
    s_mul_i32 s58, s71, 32768
    s_add_u32 s58, s58, s3
    s_lshl3_add_u32 s58, s73, s58
    s_add_u32 s55, s55, 1
    s_mov_b32 s54, 0
    s_lshr_b32 s3, s52, 1
    s_add_u32 s3, s3, 4
    s_sub_u32 s3, s3, s52
    v_bfe_u32 v1, v255, 2, 1
    v_mul_u32_u24 v1, s3, v1
    s_add_u32 s3, s72, s52
    v_add_u32 v1, s3, v1
    v_max_i32 v1, 0, v1
    s_and_b32 s3, s52, 1
    s_lshl_b32 s3, s3, 4
    s_add_u32 s3, s3, 0x19
    v_and_b32 v2, 6, v255
    v_lshrrev_b32 v3, v2, s3
    v_and_b32 v3, 3, v3
    v_mul_u32_u24 v3, 80, v3
    v_and_b32 v2, 1, v255
    v_lshl_add_u32 v3, v2, 1, v3
    v_add_u32 v3, s69, v3
    v_lshrrev_b32 v3, 2, v3
    v_lshl_add_u32 v1, v1, 6, v3
    v_lshlrev_b32 v157, 7, v1
    v_lshrrev_b32 v1, 5, v255
    v_and_b32 v2, 31, v255
    s_lshl_b32 s3, s52, 9
    s_add_u32 s3, s3, 37376
    v_lshl_add_u32 v153, v2, 4, s3
    v_mul_u32_u24 v3, 6208, v1
    v_add_u32 v152, v153, v3
    v_add_u32 v153, 12416, v153
    v_lshl_add_u32 v153, s73, 3, v153
    v_lshlrev_b32 v3, 2, v1
    v_sub_u32 v7, v2, v3
    v_bfe_u32 v4, v255, 2, 2
    v_add_u32 v3, v3, v4
    v_lshlrev_b32 v3, 4, v3
    v_and_b32 v4, 1, v255
    v_mul_u32_u24 v4, 6208, v4
    v_bfe_u32 v5, v255, 1, 1
    v_lshl_add_u32 v4, v5, 3, v4
    s_lshl_b32 s74, s73, 3
    s_add_u32 s74, s74, 12416
    v_mov_b32 v5, s74
    v_and_b32 v6, 16, v255
    v_cmp_ne_u32 vcc, 0, v6
    s_nop 1
    v_cndmask_b32 v4, v4, v5, vcc
    s_add_u32 s3, s3, 22720
    v_add3_u32 v4, v4, v3, s3
    v_add_u32 v5, 161920, v3
    v_and_b32 v6, 19, v255
    v_cmp_lt_u32 vcc, 16, v6
    s_nop 1
    v_cndmask_b32 v156, v4, v5, vcc
    v_mov_b32 v4, 512
    v_cndmask_b32 v155, v4, 0, vcc
    v_lshlrev_b32 v104, 4, v2
    v_mul_u32_u24 v158, 32768, v1
    v_add_u32 v158, v158, v104
    v_lshlrev_b32 v159, 4, v2
    v_lshlrev_b32 v105, 4, v255
    v_mov_b32 v4, 0xff800000
    s_cmp_lt_u32 s55, 9
    s_cselect_b32 s3, 0, -1
    v_mov_b32 v5, 0xffff
    v_subrev_u32 v64, 0, v7
    v_ashrrev_i32 v64, 31, v64
    v_mov_b32 v48, 0
    v_subrev_u32 v65, 1, v7
    v_ashrrev_i32 v65, 31, v65
    v_mov_b32 v49, 0
    v_subrev_u32 v66, 2, v7
    v_ashrrev_i32 v66, 31, v66
    v_mov_b32 v50, 0
    v_subrev_u32 v67, 3, v7
    v_ashrrev_i32 v67, 31, v67
    v_mov_b32 v51, 0
    v_subrev_u32 v68, 8, v7
    v_ashrrev_i32 v68, 31, v68
    v_mov_b32 v52, 0
    v_subrev_u32 v69, 9, v7
    v_ashrrev_i32 v69, 31, v69
    v_mov_b32 v53, 0
    v_subrev_u32 v70, 10, v7
    v_ashrrev_i32 v70, 31, v70
    v_mov_b32 v54, 0
    v_subrev_u32 v71, 11, v7
    v_ashrrev_i32 v71, 31, v71
    v_mov_b32 v55, 0
    v_subrev_u32 v72, 16, v7
    v_ashrrev_i32 v72, 31, v72
    v_mov_b32 v56, 0
    v_subrev_u32 v73, 17, v7
    v_ashrrev_i32 v73, 31, v73
    v_mov_b32 v57, 0
    v_subrev_u32 v74, 18, v7
    v_ashrrev_i32 v74, 31, v74
    v_mov_b32 v58, 0
    v_subrev_u32 v75, 19, v7
    v_ashrrev_i32 v75, 31, v75
    v_mov_b32 v59, 0
    v_subrev_u32 v76, 24, v7
    v_ashrrev_i32 v76, 31, v76
    v_mov_b32 v60, 0
    v_subrev_u32 v77, 25, v7
    v_ashrrev_i32 v77, 31, v77
    v_mov_b32 v61, 0
    v_subrev_u32 v78, 26, v7
    v_ashrrev_i32 v78, 31, v78
    v_mov_b32 v62, 0
    v_subrev_u32 v79, 27, v7
    v_ashrrev_i32 v79, 31, v79
    v_mov_b32 v63, 0
    v_bitop3_b32 v88, v5, v64, v65 bitop3:0xca
    v_not_b32 v80, v88
    v_and_b32 v88, s3, v88
    v_bitop3_b32 v89, v5, v66, v67 bitop3:0xca
    v_not_b32 v81, v89
    v_and_b32 v89, s3, v89
    v_bitop3_b32 v90, v5, v68, v69 bitop3:0xca
    v_not_b32 v82, v90
    v_and_b32 v90, s3, v90
    v_bitop3_b32 v91, v5, v70, v71 bitop3:0xca
    v_not_b32 v83, v91
    v_and_b32 v91, s3, v91
    v_bitop3_b32 v92, v5, v72, v73 bitop3:0xca
    v_not_b32 v84, v92
    v_and_b32 v92, s3, v92
    v_bitop3_b32 v93, v5, v74, v75 bitop3:0xca
    v_not_b32 v85, v93
    v_and_b32 v93, s3, v93
    v_bitop3_b32 v94, v5, v76, v77 bitop3:0xca
    v_not_b32 v86, v94
    v_and_b32 v94, s3, v94
    v_bitop3_b32 v95, v5, v78, v79 bitop3:0xca
    v_not_b32 v87, v95
    v_and_b32 v95, s3, v95
LX_afterA:
    v_mov_b32 v1, 160804
    s_mov_b32 s83, 0
Lspin_33:
    ds_read_b32 v2, v1
    s_add_u32 s83, s83, 1
    s_waitcnt lgkmcnt(0)
    v_readfirstlane_b32 s82, v2
    s_cmp_gt_u32 s83, 1600000
    s_cbranch_scc1 Lspd_34
    s_cmp_lt_u32 s82, 4
    s_cbranch_scc1 Lspin_33
Lspd_34:
    s_add_u32 s68, s49, 8
    s_and_b32 s73, s48, 1
    s_lshr_b32 s69, s48, 1
    s_mul_i32 s69, s69, 5
    s_add_u32 s71, s69, 2
    s_mul_i32 s3, s73, 3
    s_add_u32 s70, s69, s3
    s_lshl1_add_u32 s69, s73, s69
    s_lshl_b32 s72, s68, 1
    s_sub_u32 s72, s72, 4
    s_add_u32 s74, s72, s52
    s_max_i32 s74, s74, 0
    s_lshl_b32 s74, s74, 10
    s_lshl_b32 s77, s52, 10
    s_add_u32 s77, s77, 37376
    s_lshl2_add_u32 s75, s68, s52
    s_lshl_b32 s75, s75, 9
    s_add_u32 s75, s75, 16777216
    s_lshr_b32 s3, s52, 1
    s_add_u32 s78, s72, s3
    s_add_u32 s78, s78, 4
    s_lshl_b32 s78, s78, 10
    s_lshl_b32 s79, s3, 10
    s_add_u32 s79, s79, 41472
    s_bitcmp1_b32 s52, 0
    s_cselect_b32 s3, 2621440, 0
    s_cselect_b32 s76, 18624, 0
    s_add_u32 s78, s78, s3
    s_add_u32 s79, s79, s76
    s_mul_i32 s70, s70, 32768
    s_mul_i32 s71, s71, 32768
    s_add_u32 s74, s74, 19398656
    s_add_u32 s78, s78, 19398656
    s_mov_b32 s80, 65536
    s_mov_b64 exec, 0xff
    s_mov_b32 s83, 0
Lpoll_35:
    buffer_load_dword v96, v157, s[40:43], s80 offen sc1
    s_add_u32 s83, s83, 1
    s_waitcnt vmcnt(0)
    v_cmp_ne_u32 vcc, s6, v96
    s_cbranch_vccz Lpd_36
    s_cmp_lt_u32 s83, 200000
    s_cbranch_scc1 Lpoll_35
Lpd_36:
    s_mov_b64 exec, -1
    s_add_u32 s3, s70, s78
    s_add_u32 m0, s79, 0
    s_add_u32 s76, s70, s75
    buffer_load_dwordx4 v105, s[40:43], s3 offen sc1 lds
    buffer_load_dwordx4 v[144:147], v158, s[40:43], s76 offen sc1
    s_add_u32 s3, s70, s78
    s_add_u32 s3, s3, 32768
    s_add_u32 m0, s79, 6208
    s_add_u32 s76, s70, s75
    buffer_load_dwordx4 v105, s[40:43], s3 offen sc1 lds
    s_add_u32 s3, s71, s78
    s_add_u32 m0, s79, 12416
    s_add_u32 s76, s71, s75
    buffer_load_dwordx4 v105, s[40:43], s3 offen sc1 lds
    buffer_load_dwordx4 v[148:151], v104, s[40:43], s76 offen sc1
    s_add_u32 s76, s70, s74
    s_add_u32 m0, s77, 0
    s_add_u32 s3, s76, 2621440
    buffer_load_dwordx4 v105, s[40:43], s76 offen sc1 lds
    s_add_u32 m0, s77, 18624
    s_nop 0
    buffer_load_dwordx4 v105, s[40:43], s3 offen sc1 lds
    s_add_u32 s76, s70, s74
    s_add_u32 s76, s76, 32768
    s_add_u32 m0, s77, 6208
    s_add_u32 s3, s76, 2621440
    buffer_load_dwordx4 v105, s[40:43], s76 offen sc1 lds
    s_add_u32 m0, s77, 24832
    s_nop 0
    buffer_load_dwordx4 v105, s[40:43], s3 offen sc1 lds
    s_add_u32 s76, s71, s74
    s_add_u32 m0, s77, 12416
    s_add_u32 s3, s76, 2621440
    buffer_load_dwordx4 v105, s[40:43], s76 offen sc1 lds
    s_add_u32 m0, s77, 31040
    s_nop 0
    buffer_load_dwordx4 v105, s[40:43], s3 offen sc1 lds
    v_mov_b32 v1, 160788
    v_mov_b32 v2, 1
    s_mov_b64 exec, 1
    ds_add_u32 v1, v2
    s_mov_b64 exec, -1
    v_mov_b32 v1, 160788
    s_mov_b32 s83, 0
Lspin_37:
    ds_read_b32 v2, v1
    s_add_u32 s83, s83, 1
    s_waitcnt lgkmcnt(0)
    v_readfirstlane_b32 s82, v2
    s_cmp_gt_u32 s83, 1600000
    s_cbranch_scc1 Lspd_38
    s_cmp_lt_u32 s82, 8
    s_cbranch_scc1 Lspin_37
Lspd_38:
    v_lshrrev_b32 v1, 3, v255
    v_mul_u32_u24 v1, 3456, v1
    v_and_b32 v2, 7, v255
    v_lshl_add_u32 v1, v2, 7, v1
    s_lshl2_add_u32 s68, s45, s52
    s_mul_i32 s68, s68, 17280
    s_lshl_b32 s3, s44, 9
    s_sub_u32 s3, s3, 512
    s_lshl_b32 s69, s44, 8
    s_mov_b32 s70, 0x0f0f0f0f
    s_cmp_eq_u32 s44, 7
    s_cselect_b32 s70, 0x07070707, s70
    s_cmp_lt_u32 s44, 2
    s_cselect_b32 s3, s69, s3
    s_cselect_b32 s70, 0x03030303, s70
    s_add_u32 s68, s68, s3
    s_mov_b32 exec_lo, s70
    s_and_b32 exec_hi, s70, 0xff
    buffer_load_dword v242, v1, s[24:27], s68 offen
    buffer_load_dword v242, v1, s[28:31], s68 offen
    s_mov_b64 exec, -1
    v_mov_b32 v1, 160776
    v_mov_b32 v2, 1
    s_waitcnt vmcnt(2)
    s_mov_b64 exec, 1
    ds_add_u32 v1, v2
    s_bitcmp1_b32 s48, 0
    s_cselect_b32 exec_lo, -1, 0
    s_mov_b32 exec_hi, 0
    v_mov_b32 v148, v150
    v_mov_b32 v149, v151
    s_mov_b32 exec_lo, 0x0
    s_mov_b32 exec_hi, 0xffffffff
    v_mov_b32 v148, 0
    v_mov_b32 v149, 0
    s_mov_b64 exec, -1
    v_mov_b32 v150, 0
    v_mov_b32 v151, 0
    v_mov_b32 v118, 0
    v_mov_b32 v119, 0
    v_mov_b32 v126, 0
    v_mov_b32 v127, 0
    v_mov_b32 v1, 160776
    s_mov_b32 s83, 0
Lspin_39:
    ds_read_b32 v2, v1
    s_add_u32 s83, s83, 1
    s_waitcnt lgkmcnt(0)
    v_readfirstlane_b32 s82, v2
    s_cmp_gt_u32 s83, 1600000
    s_cbranch_scc1 Lspd_40
    s_cmp_lt_u32 s82, 4
    s_cbranch_scc1 Lspin_39
Lspd_40:
LB_main0:
    ds_read_b128 v[112:115], v152 offset:4096
    ds_read_b64 v[116:117], v153 offset:4096
    ds_read_b128 v[120:123], v152
    ds_read_b64 v[124:125], v153
    v_lshlrev_b32 v154, 3, v155
    v_sub_u32 v154, v156, v154
    ds_read_b64_tr_b16 v[136:137], v154 offset:0
    ds_read_b64_tr_b16 v[138:139], v154 offset:128
    ds_read_b64_tr_b16 v[140:141], v154 offset:256
    ds_read_b64_tr_b16 v[142:143], v154 offset:384
    ds_read_b64_tr_b16 v[128:129], v156 offset:0
    ds_read_b64_tr_b16 v[130:131], v156 offset:128
    ds_read_b64_tr_b16 v[132:133], v156 offset:256
    ds_read_b64_tr_b16 v[134:135], v156 offset:384
    v_sub_u32 v154, v156, v155
    s_waitcnt lgkmcnt(10)
    v_mfma_f32_32x32x16_bf16 v[0:15], v[112:115], v[144:147], v[48:63]
    v_mfma_f32_32x32x16_bf16 v[0:15], v[116:119], v[148:151], v[0:15]
    s_waitcnt lgkmcnt(8)
    v_mfma_f32_32x32x16_bf16 v[16:31], v[120:123], v[144:147], v[48:63]
    v_mfma_f32_32x32x16_bf16 v[16:31], v[124:127], v[148:151], v[16:31]
    ds_read_b128 v[112:115], v152 offset:3072
    ds_read_b64 v[116:117], v153 offset:3072
    ds_read_b128 v[120:123], v152 offset:3584
    ds_read_b64 v[124:125], v153 offset:3584
    s_nop 7
    v_bitop3_b32 v0, v64, v16, v0 bitop3:0xca
    v_bitop3_b32 v1, v65, v17, v1 bitop3:0xca
    v_bitop3_b32 v2, v66, v18, v2 bitop3:0xca
    v_bitop3_b32 v3, v67, v19, v3 bitop3:0xca
    v_bitop3_b32 v4, v68, v20, v4 bitop3:0xca
    v_bitop3_b32 v5, v69, v21, v5 bitop3:0xca
    v_bitop3_b32 v6, v70, v22, v6 bitop3:0xca
    v_bitop3_b32 v7, v71, v23, v7 bitop3:0xca
    v_bitop3_b32 v8, v72, v24, v8 bitop3:0xca
    v_bitop3_b32 v9, v73, v25, v9 bitop3:0xca
    v_bitop3_b32 v10, v74, v26, v10 bitop3:0xca
    v_bitop3_b32 v11, v75, v27, v11 bitop3:0xca
    v_bitop3_b32 v12, v76, v28, v12 bitop3:0xca
    v_bitop3_b32 v13, v77, v29, v13 bitop3:0xca
    v_bitop3_b32 v14, v78, v30, v14 bitop3:0xca
    v_bitop3_b32 v15, v79, v31, v15 bitop3:0xca
    s_waitcnt lgkmcnt(0)
    v_exp_f32 v0, v0
    v_exp_f32 v1, v1
    v_exp_f32 v2, v2
    v_exp_f32 v3, v3
    v_mfma_f32_32x32x16_bf16 v[16:31], v[120:123], v[144:147], v[48:63]
    v_exp_f32 v4, v4
    v_exp_f32 v5, v5
    v_exp_f32 v6, v6
    v_exp_f32 v7, v7
    v_mfma_f32_32x32x16_bf16 v[16:31], v[124:127], v[148:151], v[16:31]
    v_cvt_pk_bf16_f32 v96, v0, v1
    v_cvt_pk_bf16_f32 v97, v2, v3
    v_cvt_pk_bf16_f32 v98, v4, v5
    v_cvt_pk_bf16_f32 v99, v6, v7
    v_and_b32 v104, v96, v88
    v_and_b32 v96, v96, v80
    v_and_b32 v105, v97, v89
    v_and_b32 v97, v97, v81
    v_and_b32 v106, v98, v90
    v_and_b32 v98, v98, v82
    v_and_b32 v107, v99, v91
    v_and_b32 v99, v99, v83
    v_exp_f32 v8, v8
    v_exp_f32 v9, v9
    v_exp_f32 v10, v10
    v_exp_f32 v11, v11
    v_mfma_f32_32x32x16_bf16 v[32:47], v[128:131], v[96:99], 0
    v_exp_f32 v12, v12
    v_exp_f32 v13, v13
    v_exp_f32 v14, v14
    v_exp_f32 v15, v15
    v_mfma_f32_32x32x16_bf16 v[32:47], v[136:139], v[104:107], v[32:47]
    v_cvt_pk_bf16_f32 v100, v8, v9
    v_cvt_pk_bf16_f32 v101, v10, v11
    v_cvt_pk_bf16_f32 v102, v12, v13
    v_cvt_pk_bf16_f32 v103, v14, v15
    v_and_b32 v108, v100, v92
    v_and_b32 v100, v100, v84
    v_and_b32 v109, v101, v93
    v_and_b32 v101, v101, v85
    v_and_b32 v110, v102, v94
    v_and_b32 v102, v102, v86
    v_and_b32 v111, v103, v95
    v_and_b32 v103, v103, v87
    s_nop 0
    v_mfma_f32_32x32x16_bf16 v[32:47], v[140:143], v[108:111], v[32:47]
    ds_read_b64_tr_b16 v[136:137], v154 offset:0
    ds_read_b64_tr_b16 v[138:139], v154 offset:128
    ds_read_b64_tr_b16 v[140:141], v154 offset:256
    ds_read_b64_tr_b16 v[142:143], v154 offset:384
    v_sub_u32 v154, v154, v155
    v_mfma_f32_32x32x16_bf16 v[32:47], v[132:135], v[100:103], v[32:47]
    s_waitcnt lgkmcnt(4)
    v_exp_f32 v16, v16
    v_exp_f32 v17, v17
    v_exp_f32 v18, v18
    v_exp_f32 v19, v19
    v_mfma_f32_32x32x16_bf16 v[0:15], v[112:115], v[144:147], v[48:63]
    ds_read_b128 v[120:123], v152 offset:2560
    ds_read_b64 v[124:125], v153 offset:2560
    v_exp_f32 v20, v20
    v_exp_f32 v21, v21
    v_exp_f32 v22, v22
    v_exp_f32 v23, v23
    v_mfma_f32_32x32x16_bf16 v[0:15], v[116:119], v[148:151], v[0:15]
    ds_read_b64_tr_b16 v[128:129], v154 offset:0
    ds_read_b64_tr_b16 v[130:131], v154 offset:128
    s_waitcnt lgkmcnt(4)
    v_cvt_pk_bf16_f32 v96, v16, v17
    v_cvt_pk_bf16_f32 v97, v18, v19
    v_cvt_pk_bf16_f32 v98, v20, v21
    v_cvt_pk_bf16_f32 v99, v22, v23
    v_exp_f32 v24, v24
    v_exp_f32 v25, v25
    v_exp_f32 v26, v26
    v_exp_f32 v27, v27
    v_mfma_f32_32x32x16_bf16 v[32:47], v[136:139], v[96:99], v[32:47]
    ds_read_b64_tr_b16 v[132:133], v154 offset:256
    ds_read_b64_tr_b16 v[134:135], v154 offset:384
    v_exp_f32 v28, v28
    v_exp_f32 v29, v29
    v_exp_f32 v30, v30
    v_exp_f32 v31, v31
    v_cvt_pk_bf16_f32 v100, v24, v25
    v_cvt_pk_bf16_f32 v101, v26, v27
    v_cvt_pk_bf16_f32 v102, v28, v29
    v_cvt_pk_bf16_f32 v103, v30, v31
    v_sub_u32 v154, v154, v155
    s_nop 0
    v_mfma_f32_32x32x16_bf16 v[32:47], v[140:143], v[100:103], v[32:47]
    s_waitcnt lgkmcnt(0)
    v_exp_f32 v0, v0
    v_exp_f32 v1, v1
    v_exp_f32 v2, v2
    v_exp_f32 v3, v3
    v_mfma_f32_32x32x16_bf16 v[16:31], v[120:123], v[144:147], v[48:63]
    ds_read_b128 v[112:115], v152 offset:2048
    ds_read_b64 v[116:117], v153 offset:2048
    v_exp_f32 v4, v4
    v_exp_f32 v5, v5
    v_exp_f32 v6, v6
    v_exp_f32 v7, v7
    v_mfma_f32_32x32x16_bf16 v[16:31], v[124:127], v[148:151], v[16:31]
    ds_read_b64_tr_b16 v[136:137], v154 offset:0
    ds_read_b64_tr_b16 v[138:139], v154 offset:128
    v_cvt_pk_bf16_f32 v96, v0, v1
    v_cvt_pk_bf16_f32 v97, v2, v3
    v_cvt_pk_bf16_f32 v98, v4, v5
    v_cvt_pk_bf16_f32 v99, v6, v7
    v_exp_f32 v8, v8
    v_exp_f32 v9, v9
    v_exp_f32 v10, v10
    v_exp_f32 v11, v11
    v_mfma_f32_32x32x16_bf16 v[32:47], v[128:131], v[96:99], v[32:47]
    ds_read_b64_tr_b16 v[140:141], v154 offset:256
    ds_read_b64_tr_b16 v[142:143], v154 offset:384
    v_exp_f32 v12, v12
    v_exp_f32 v13, v13
    v_exp_f32 v14, v14
    v_exp_f32 v15, v15
    v_cvt_pk_bf16_f32 v100, v8, v9
    v_cvt_pk_bf16_f32 v101, v10, v11
    v_cvt_pk_bf16_f32 v102, v12, v13
    v_cvt_pk_bf16_f32 v103, v14, v15
    v_sub_u32 v154, v154, v155
    s_nop 0
    v_mfma_f32_32x32x16_bf16 v[32:47], v[132:135], v[100:103], v[32:47]
    s_waitcnt lgkmcnt(0)
    v_exp_f32 v16, v16
    v_exp_f32 v17, v17
    v_exp_f32 v18, v18
    v_exp_f32 v19, v19
    v_mfma_f32_32x32x16_bf16 v[0:15], v[112:115], v[144:147], v[48:63]
    ds_read_b128 v[120:123], v152 offset:1536
    ds_read_b64 v[124:125], v153 offset:1536
    v_exp_f32 v20, v20
    v_exp_f32 v21, v21
    v_exp_f32 v22, v22
    v_exp_f32 v23, v23
    v_mfma_f32_32x32x16_bf16 v[0:15], v[116:119], v[148:151], v[0:15]
    ds_read_b64_tr_b16 v[128:129], v154 offset:0
    ds_read_b64_tr_b16 v[130:131], v154 offset:128
    v_cvt_pk_bf16_f32 v96, v16, v17
    v_cvt_pk_bf16_f32 v97, v18, v19
    v_cvt_pk_bf16_f32 v98, v20, v21
    v_cvt_pk_bf16_f32 v99, v22, v23
    v_exp_f32 v24, v24
    v_exp_f32 v25, v25
    v_exp_f32 v26, v26
    v_exp_f32 v27, v27
    v_mfma_f32_32x32x16_bf16 v[32:47], v[136:139], v[96:99], v[32:47]
    ds_read_b64_tr_b16 v[132:133], v154 offset:256
    ds_read_b64_tr_b16 v[134:135], v154 offset:384
    v_exp_f32 v28, v28
    v_exp_f32 v29, v29
    v_exp_f32 v30, v30
    v_exp_f32 v31, v31
    v_cvt_pk_bf16_f32 v100, v24, v25
    v_cvt_pk_bf16_f32 v101, v26, v27
    v_cvt_pk_bf16_f32 v102, v28, v29
    v_cvt_pk_bf16_f32 v103, v30, v31
    v_sub_u32 v154, v154, v155
    s_nop 0
    v_mfma_f32_32x32x16_bf16 v[32:47], v[140:143], v[100:103], v[32:47]
    s_waitcnt lgkmcnt(0)
    v_exp_f32 v0, v0
    v_exp_f32 v1, v1
    v_exp_f32 v2, v2
    v_exp_f32 v3, v3
    v_mfma_f32_32x32x16_bf16 v[16:31], v[120:123], v[144:147], v[48:63]
    ds_read_b128 v[112:115], v152 offset:1024
    ds_read_b64 v[116:117], v153 offset:1024
    v_exp_f32 v4, v4
    v_exp_f32 v5, v5
    v_exp_f32 v6, v6
    v_exp_f32 v7, v7
    v_mfma_f32_32x32x16_bf16 v[16:31], v[124:127], v[148:151], v[16:31]
    ds_read_b64_tr_b16 v[136:137], v154 offset:0
    ds_read_b64_tr_b16 v[138:139], v154 offset:128
    v_cvt_pk_bf16_f32 v96, v0, v1
    v_cvt_pk_bf16_f32 v97, v2, v3
    v_cvt_pk_bf16_f32 v98, v4, v5
    v_cvt_pk_bf16_f32 v99, v6, v7
    v_exp_f32 v8, v8
    v_exp_f32 v9, v9
    v_exp_f32 v10, v10
    v_exp_f32 v11, v11
    v_mfma_f32_32x32x16_bf16 v[32:47], v[128:131], v[96:99], v[32:47]
    ds_read_b64_tr_b16 v[140:141], v154 offset:256
    ds_read_b64_tr_b16 v[142:143], v154 offset:384
    v_exp_f32 v12, v12
    v_exp_f32 v13, v13
    v_exp_f32 v14, v14
    v_exp_f32 v15, v15
    v_cvt_pk_bf16_f32 v100, v8, v9
    v_cvt_pk_bf16_f32 v101, v10, v11
    v_cvt_pk_bf16_f32 v102, v12, v13
    v_cvt_pk_bf16_f32 v103, v14, v15
    v_sub_u32 v154, v154, v155
    s_nop 0
    v_mfma_f32_32x32x16_bf16 v[32:47], v[132:135], v[100:103], v[32:47]
    s_waitcnt lgkmcnt(0)
    v_exp_f32 v16, v16
    v_exp_f32 v17, v17
    v_exp_f32 v18, v18
    v_exp_f32 v19, v19
    v_mfma_f32_32x32x16_bf16 v[0:15], v[112:115], v[144:147], v[48:63]
    ds_read_b128 v[120:123], v152 offset:512
    ds_read_b64 v[124:125], v153 offset:512
    v_exp_f32 v20, v20
    v_exp_f32 v21, v21
    v_exp_f32 v22, v22
    v_exp_f32 v23, v23
    v_mfma_f32_32x32x16_bf16 v[0:15], v[116:119], v[148:151], v[0:15]
    ds_read_b64_tr_b16 v[128:129], v154 offset:0
    ds_read_b64_tr_b16 v[130:131], v154 offset:128
    v_cvt_pk_bf16_f32 v96, v16, v17
    v_cvt_pk_bf16_f32 v97, v18, v19
    v_cvt_pk_bf16_f32 v98, v20, v21
    v_cvt_pk_bf16_f32 v99, v22, v23
    v_exp_f32 v24, v24
    v_exp_f32 v25, v25
    v_exp_f32 v26, v26
    v_exp_f32 v27, v27
    v_mfma_f32_32x32x16_bf16 v[32:47], v[136:139], v[96:99], v[32:47]
    ds_read_b64_tr_b16 v[132:133], v154 offset:256
    ds_read_b64_tr_b16 v[134:135], v154 offset:384
    v_exp_f32 v28, v28
    v_exp_f32 v29, v29
    v_exp_f32 v30, v30
    v_exp_f32 v31, v31
    v_cvt_pk_bf16_f32 v100, v24, v25
    v_cvt_pk_bf16_f32 v101, v26, v27
    v_cvt_pk_bf16_f32 v102, v28, v29
    v_cvt_pk_bf16_f32 v103, v30, v31
    v_sub_u32 v154, v154, v155
    s_nop 0
    v_mfma_f32_32x32x16_bf16 v[32:47], v[140:143], v[100:103], v[32:47]
    s_waitcnt lgkmcnt(0)
    v_exp_f32 v0, v0
    v_exp_f32 v1, v1
    v_exp_f32 v2, v2
    v_exp_f32 v3, v3
    v_mfma_f32_32x32x16_bf16 v[16:31], v[120:123], v[144:147], v[48:63]
    v_exp_f32 v4, v4
    v_exp_f32 v5, v5
    v_exp_f32 v6, v6
    v_exp_f32 v7, v7
    v_mfma_f32_32x32x16_bf16 v[16:31], v[124:127], v[148:151], v[16:31]
    ds_read_b64_tr_b16 v[136:137], v154 offset:0
    ds_read_b64_tr_b16 v[138:139], v154 offset:128
    v_cvt_pk_bf16_f32 v96, v0, v1
    v_cvt_pk_bf16_f32 v97, v2, v3
    v_cvt_pk_bf16_f32 v98, v4, v5
    v_cvt_pk_bf16_f32 v99, v6, v7
    v_exp_f32 v8, v8
    v_exp_f32 v9, v9
    v_exp_f32 v10, v10
    v_exp_f32 v11, v11
    v_mfma_f32_32x32x16_bf16 v[32:47], v[128:131], v[96:99], v[32:47]
    ds_read_b64_tr_b16 v[140:141], v154 offset:256
    ds_read_b64_tr_b16 v[142:143], v154 offset:384
    v_exp_f32 v12, v12
    v_exp_f32 v13, v13
    v_exp_f32 v14, v14
    v_exp_f32 v15, v15
    v_cvt_pk_bf16_f32 v100, v8, v9
    v_cvt_pk_bf16_f32 v101, v10, v11
    v_cvt_pk_bf16_f32 v102, v12, v13
    v_cvt_pk_bf16_f32 v103, v14, v15
    s_nop 1
    v_mfma_f32_32x32x16_bf16 v[32:47], v[132:135], v[100:103], v[32:47]
    s_waitcnt lgkmcnt(0)
    v_exp_f32 v16, v16
    v_exp_f32 v17, v17
    v_exp_f32 v18, v18
    v_exp_f32 v19, v19
    v_exp_f32 v20, v20
    v_exp_f32 v21, v21
    v_exp_f32 v22, v22
    v_exp_f32 v23, v23
    v_cvt_pk_bf16_f32 v96, v16, v17
    v_cvt_pk_bf16_f32 v97, v18, v19
    v_cvt_pk_bf16_f32 v98, v20, v21
    v_cvt_pk_bf16_f32 v99, v22, v23
    v_exp_f32 v24, v24
    v_exp_f32 v25, v25
    v_exp_f32 v26, v26
    v_exp_f32 v27, v27
    v_mfma_f32_32x32x16_bf16 v[32:47], v[136:139], v[96:99], v[32:47]
    v_exp_f32 v28, v28
    v_exp_f32 v29, v29
    v_exp_f32 v30, v30
    v_exp_f32 v31, v31
    v_cvt_pk_bf16_f32 v100, v24, v25
    v_cvt_pk_bf16_f32 v101, v26, v27
    v_cvt_pk_bf16_f32 v102, v28, v29
    v_cvt_pk_bf16_f32 v103, v30, v31
    s_nop 1
    v_mfma_f32_32x32x16_bf16 v[32:47], v[140:143], v[100:103], v[32:47]
LB_chk:
    s_mov_b32 s3, 0x1f800000
    s_mov_b32 s74, 0x5f800000
    s_nop 9
    v_cmp_lt_f32 vcc, s3, v44
    v_cmp_gt_f32 s[76:77], s74, v44
    v_rcp_f32 v45, v44
    s_and_b64 vcc, vcc, s[76:77]
    s_cmp_eq_u64 vcc, -1
    s_cbranch_scc0 LB_slow
LB_fin:
    v_mul_f32 v46, 0x3f7f4ccd, v45
    v_mul_f32 v32, v32, v46
    v_mul_f32 v33, v33, v45
    v_mul_f32 v34, v34, v45
    v_mul_f32 v35, v35, v45
    v_mul_f32 v36, v36, v46
    v_mul_f32 v37, v37, v45
    v_mul_f32 v38, v38, v45
    v_mul_f32 v39, v39, v45
    v_cvt_pk_bf16_f32 v96, v32, v33
    v_cvt_pk_bf16_f32 v97, v34, v35
    v_cvt_pk_bf16_f32 v98, v36, v37
    v_cvt_pk_bf16_f32 v99, v38, v39
    v_or_b32 v96, 1, v96
    v_or_b32 v98, 1, v98
    buffer_store_dwordx4 v[96:99], v158, s[40:43], s57 offen sc1
    v_mul_f32 v40, v40, v46
    v_mul_f32 v41, v41, v45
    v_mul_f32 v42, v42, v45
    v_mul_f32 v43, v43, v45
    v_cvt_pk_bf16_f32 v100, v40, v41
    v_cvt_pk_bf16_f32 v101, v42, v43
    v_or_b32 v100, 1, v100
    s_mov_b32 exec_hi, 0
    buffer_store_dwordx2 v[100:101], v159, s[40:43], s58 offen sc1
    s_mov_b64 exec, -1
    s_setprio 0
    v_mov_b32 v1, 160780
    v_mov_b32 v2, 1
    s_mov_b64 exec, 1
    ds_add_u32 v1, v2
    s_mov_b64 exec, -1
    v_lshrrev_b32 v126, 3, v255
    v_and_b32 v127, 7, v255
    v_mul_u32_u24 v197, 1280, v126
    v_lshl_add_u32 v196, v127, 4, v197
    v_lshl_add_u32 v197, v127, 2, v197
    s_mul_i32 s3, s52, 2688
    s_mul_i32 s68, s53, 10752
    s_add_u32 s3, s3, s68
    s_add_u32 s3, s3, 74752
    v_mul_u32_u24 v199, 336, v126
    v_add_u32 v199, s3, v199
    v_lshl_add_u32 v198, v127, 5, v199
    v_lshl_add_u32 v199, v127, 3, v199
    v_lshlrev_b32 v126, 4, v127
    v_lshlrev_b32 v127, 2, v127
    v_lshlrev_b32 v128, 4, v255
    buffer_load_dwordx4 v[112:115], v126, s[20:23], s60 offen
    buffer_load_dword v116, v127, s[20:23], s60 offen offset:128
    buffer_load_dwordx4 v[118:121], v128, s[20:23], 0 offen
    buffer_load_dwordx4 v[122:125], v128, s[20:23], 0 offen offset:1024
    buffer_load_dwordx4 v[210:213], v196, s[8:11], s61 offen
    buffer_load_dword v214, v197, s[8:11], s61 offen offset:128
    s_cmp_eq_u32 s53, 0
    s_cbranch_scc1 LC_X
    s_setprio 2
    v_mov_b32 v195, s6
    s_mov_b64 exec, 0xffff
    buffer_load_dword v195, v193, s[40:43], s66 offen sc1
    s_mov_b64 exec, -1
    s_waitcnt vmcnt(9)
    ds_read_b64_tr_b16 v[0:1], v190 offset:0
    ds_read_b64_tr_b16 v[2:3], v190 offset:640
    ds_read_b64_tr_b16 v[4:5], v190 offset:32
    ds_read_b64_tr_b16 v[6:7], v190 offset:672
    ds_read_b64_tr_b16 v[8:9], v190 offset:64
    ds_read_b64_tr_b16 v[10:11], v190 offset:704
    ds_read_b64_tr_b16 v[12:13], v190 offset:96
    ds_read_b64_tr_b16 v[14:15], v190 offset:736
    ds_read_b64_tr_b16 v[16:17], v190 offset:128
    ds_read_b64_tr_b16 v[18:19], v190 offset:768
    s_waitcnt lgkmcnt(0)
    ds_read_b64_tr_b16 v[20:21], v190 offset:5120
    ds_read_b64_tr_b16 v[22:23], v190 offset:5760
    ds_read_b64_tr_b16 v[24:25], v190 offset:5152
    ds_read_b64_tr_b16 v[26:27], v190 offset:5792
    ds_read_b64_tr_b16 v[28:29], v190 offset:5184
    ds_read_b64_tr_b16 v[30:31], v190 offset:5824
    ds_read_b64_tr_b16 v[32:33], v190 offset:5216
    ds_read_b64_tr_b16 v[34:35], v190 offset:5856
    ds_read_b64_tr_b16 v[36:37], v190 offset:5248
    ds_read_b64_tr_b16 v[38:39], v190 offset:5888
    s_waitcnt lgkmcnt(0)
    ds_read_b64_tr_b16 v[40:41], v190 offset:10240
    ds_read_b64_tr_b16 v[42:43], v190 offset:10880
    ds_read_b64_tr_b16 v[44:45], v190 offset:10272
    ds_read_b64_tr_b16 v[46:47], v190 offset:10912
    ds_read_b64_tr_b16 v[48:49], v190 offset:10304
    ds_read_b64_tr_b16 v[50:51], v190 offset:10944
    ds_read_b64_tr_b16 v[52:53], v190 offset:10336
    ds_read_b64_tr_b16 v[54:55], v190 offset:10976
    ds_read_b64_tr_b16 v[56:57], v190 offset:10368
    ds_read_b64_tr_b16 v[58:59], v190 offset:11008
    s_waitcnt lgkmcnt(0)
    s_waitcnt vmcnt(1)
    v_lshlrev_b32 v200, 16, v112
    v_and_b32 v201, 0xffff0000, v112
    v_lshlrev_b32 v202, 16, v113
    v_and_b32 v203, 0xffff0000, v113
    v_lshlrev_b32 v204, 16, v114
    v_and_b32 v205, 0xffff0000, v114
    v_lshlrev_b32 v206, 16, v115
    v_and_b32 v207, 0xffff0000, v115
    v_lshlrev_b32 v208, 16, v116
    v_and_b32 v209, 0xffff0000, v116
    v_lshlrev_b32 v130, 16, v118
    v_and_b32 v131, 0xffff0000, v118
    v_lshlrev_b32 v132, 16, v119
    v_and_b32 v133, 0xffff0000, v119
    v_lshlrev_b32 v134, 16, v120
    v_and_b32 v135, 0xffff0000, v120
    v_lshlrev_b32 v136, 16, v121
    v_and_b32 v137, 0xffff0000, v121
    v_lshlrev_b32 v138, 16, v122
    v_and_b32 v139, 0xffff0000, v122
    v_lshlrev_b32 v140, 16, v123
    v_and_b32 v141, 0xffff0000, v123
    v_lshlrev_b32 v142, 16, v124
    v_and_b32 v143, 0xffff0000, v124
    v_lshlrev_b32 v144, 16, v125
    v_and_b32 v145, 0xffff0000, v125
    v_add_f32 v130, v130, v138
    v_add_f32 v131, v131, v139
    v_add_f32 v132, v132, v140
    v_add_f32 v133, v133, v141
    v_add_f32 v134, v134, v142
    v_add_f32 v135, v135, v143
    v_add_f32 v136, v136, v144
    v_add_f32 v137, v137, v145
    v_add_f32 v130, v130, v134
    v_add_f32 v131, v131, v135
    v_add_f32 v132, v132, v136
    v_add_f32 v133, v133, v137
    v_add_f32 v130, v130, v132
    v_add_f32 v131, v131, v133
    v_add_f32 v130, v130, v131
    s_nop 1
    v_add_f32_dpp v130, v130, v130 quad_perm:[1,0,3,2] row_mask:0xf bank_mask:0xf
    s_nop 1
    v_add_f32_dpp v130, v130, v130 quad_perm:[2,3,0,1] row_mask:0xf bank_mask:0xf
    s_nop 1
    v_add_f32_dpp v130, v130, v130 row_half_mirror row_mask:0xf bank_mask:0xf
    s_nop 1
    v_add_f32_dpp v130, v130, v130 row_mirror row_mask:0xf bank_mask:0xf
    v_mov_b32 v131, v130
    s_nop 1
    v_permlane16_swap_b32 v130, v131
    v_add_f32 v130, v130, v131
    v_mov_b32 v131, v130
    s_nop 1
    v_permlane32_swap_b32 v130, v131
    v_add_f32 v130, v130, v131
    s_nop 0
    v_readfirstlane_b32 s56, v130
    s_add_u32 s68, s65, 0
    s_add_u32 s69, s65, 131072
    s_add_u32 s70, s65, 262144
    s_add_u32 s71, s65, 393216
    s_add_u32 s72, s65, 524288
    s_add_u32 s73, s65, 16384
    s_add_u32 s74, s65, 147456
    s_add_u32 s75, s65, 278528
    s_add_u32 s76, s65, 409600
    s_add_u32 s77, s65, 540672
    s_add_u32 s78, s65, 65536
    s_waitcnt vmcnt(0)
    v_cmp_ne_u32 vcc, s6, v195
    s_mov_b64 exec, 0xffff
    s_cbranch_vccz LC_marked
    s_mov_b32 s83, 0
Lpoll_41:
    buffer_load_dword v195, v193, s[40:43], s66 offen sc1
    s_add_u32 s83, s83, 1
    s_waitcnt vmcnt(0)
    v_cmp_ne_u32 vcc, s6, v195
    s_cbranch_vccz Lpd_42
    s_cmp_lt_u32 s83, 200000
    s_cbranch_scc1 Lpoll_41
Lpd_42:
LC_marked:
    s_mov_b32 s83, 0
Lpoll_43:
    buffer_load_dword v195, v192, s[40:43], s78 offen offset:496 sc1
    s_add_u32 s83, s83, 1
    s_waitcnt vmcnt(0)
    v_and_b32 v195, 1, v195
    v_cmp_eq_u32 vcc, 0, v195
    s_and_b32 s80, vcc_lo, 65280
    s_and_b64 vcc, vcc, 255
    s_cbranch_vccz Lpd_44
    s_cmp_lt_u32 s83, 200000
    s_cbranch_scc1 Lpoll_43
Lpd_44:
LC_first:
    s_mov_b64 exec, -1
    buffer_load_dwordx4 v[100:103], v191, s[40:43], s68 offen offset:0 sc1
    buffer_load_dwordx4 v[104:107], v191, s[40:43], s69 offen offset:0 sc1
    buffer_load_dwordx4 v[108:111], v191, s[40:43], s70 offen offset:0 sc1
    buffer_load_dwordx4 v[112:115], v191, s[40:43], s71 offen offset:0 sc1
    buffer_load_dwordx4 v[116:119], v191, s[40:43], s72 offen offset:0 sc1
    buffer_load_dwordx4 v[120:123], v191, s[40:43], s68 offen offset:256 sc1
    buffer_load_dwordx4 v[124:127], v191, s[40:43], s69 offen offset:256 sc1
    buffer_load_dwordx4 v[128:131], v191, s[40:43], s70 offen offset:256 sc1
    buffer_load_dwordx4 v[132:135], v191, s[40:43], s71 offen offset:256 sc1
    buffer_load_dwordx4 v[136:139], v191, s[40:43], s72 offen offset:256 sc1
    s_cmp_lg_u32 s80, 0
    s_cbranch_scc1 LC_split
    buffer_load_dwordx4 v[140:143], v191, s[40:43], s73 offen offset:0 sc1
    buffer_load_dwordx4 v[144:147], v191, s[40:43], s74 offen offset:0 sc1
    buffer_load_dwordx4 v[148:151], v191, s[40:43], s75 offen offset:0 sc1
    buffer_load_dwordx4 v[152:155], v191, s[40:43], s76 offen offset:0 sc1
    buffer_load_dwordx4 v[156:159], v191, s[40:43], s77 offen offset:0 sc1
    buffer_load_dwordx4 v[180:183], v191, s[40:43], s73 offen offset:256 sc1
    buffer_load_dwordx4 v[184:187], v191, s[40:43], s74 offen offset:256 sc1
    buffer_load_dwordx4 v[216:219], v191, s[40:43], s75 offen offset:256 sc1
    buffer_load_dwordx4 v[240:243], v191, s[40:43], s76 offen offset:256 sc1
    buffer_load_dwordx4 v[244:247], v191, s[40:43], s77 offen offset:256 sc1
    v_mov_b32 v248, 160792
    v_mov_b32 v249, 1
    s_mov_b64 exec, 1
    ds_add_u32 v248, v249
    s_mov_b64 exec, -1
Lgrp_46:
    s_waitcnt vmcnt(19)
    v_mfma_f32_16x16x32_bf16 v[60:63], v[0:3], v[100:103], 0
    v_bitop3_b32 v250, v100, v102, 1 bitop3:0x80
    v_mfma_f32_16x16x32_bf16 v[64:67], v[4:7], v[100:103], 0
    v_mfma_f32_16x16x32_bf16 v[68:71], v[8:11], v[100:103], 0
    v_mfma_f32_16x16x32_bf16 v[72:75], v[12:15], v[100:103], 0
    v_mfma_f32_16x16x32_bf16 v[76:79], v[16:19], v[100:103], 0
    s_waitcnt vmcnt(18)
    v_mfma_f32_16x16x32_bf16 v[60:63], v[20:23], v[104:107], v[60:63]
    v_bitop3_b32 v250, v104, v106, v250 bitop3:0x80
    v_mfma_f32_16x16x32_bf16 v[64:67], v[24:27], v[104:107], v[64:67]
    v_mfma_f32_16x16x32_bf16 v[68:71], v[28:31], v[104:107], v[68:71]
    v_mfma_f32_16x16x32_bf16 v[72:75], v[32:35], v[104:107], v[72:75]
    v_mfma_f32_16x16x32_bf16 v[76:79], v[36:39], v[104:107], v[76:79]
    s_waitcnt vmcnt(17)
    v_mfma_f32_16x16x32_bf16 v[60:63], v[40:43], v[108:111], v[60:63]
    v_bitop3_b32 v250, v108, v110, v250 bitop3:0x80
    v_mfma_f32_16x16x32_bf16 v[64:67], v[44:47], v[108:111], v[64:67]
    v_mfma_f32_16x16x32_bf16 v[68:71], v[48:51], v[108:111], v[68:71]
    v_mfma_f32_16x16x32_bf16 v[72:75], v[52:55], v[108:111], v[72:75]
    v_mfma_f32_16x16x32_bf16 v[76:79], v[56:59], v[108:111], v[76:79]
    s_waitcnt vmcnt(16)
    v_mfma_f32_16x16x32_bf16 v[60:63], v[160:163], v[112:115], v[60:63]
    v_bitop3_b32 v250, v112, v114, v250 bitop3:0x80
    v_mfma_f32_16x16x32_bf16 v[64:67], v[164:167], v[112:115], v[64:67]
    v_mfma_f32_16x16x32_bf16 v[68:71], v[168:171], v[112:115], v[68:71]
    v_mfma_f32_16x16x32_bf16 v[72:75], v[172:175], v[112:115], v[72:75]
    v_mfma_f32_16x16x32_bf16 v[76:79], v[176:179], v[112:115], v[76:79]
    s_waitcnt vmcnt(15)
    v_mfma_f32_16x16x32_bf16 v[60:63], v[220:223], v[116:119], v[60:63]
    v_bitop3_b32 v250, v116, v118, v250 bitop3:0x80
    v_mfma_f32_16x16x32_bf16 v[64:67], v[224:227], v[116:119], v[64:67]
    v_mfma_f32_16x16x32_bf16 v[68:71], v[228:231], v[116:119], v[68:71]
    v_cmp_eq_u32 vcc, 0, v250
    v_mfma_f32_16x16x32_bf16 v[72:75], v[232:235], v[116:119], v[72:75]
    v_mfma_f32_16x16x32_bf16 v[76:79], v[236:239], v[116:119], v[76:79]
    s_cbranch_vccnz Lredo_45
Lgrp_48:
    s_waitcnt vmcnt(10)
    v_mfma_f32_16x16x32_bf16 v[80:83], v[0:3], v[120:123], 0
    v_bitop3_b32 v250, v120, v122, 1 bitop3:0x80
    v_mfma_f32_16x16x32_bf16 v[84:87], v[4:7], v[120:123], 0
    ds_write_b128 v194, v[60:63] offset:0
    v_mfma_f32_16x16x32_bf16 v[80:83], v[20:23], v[124:127], v[80:83]
    v_bitop3_b32 v250, v124, v126, v250 bitop3:0x80
    v_mfma_f32_16x16x32_bf16 v[84:87], v[24:27], v[124:127], v[84:87]
    ds_write_b128 v194, v[64:67] offset:64
    v_mfma_f32_16x16x32_bf16 v[80:83], v[40:43], v[128:131], v[80:83]
    v_bitop3_b32 v250, v128, v130, v250 bitop3:0x80
    v_mfma_f32_16x16x32_bf16 v[84:87], v[44:47], v[128:131], v[84:87]
    ds_write_b128 v194, v[68:71] offset:128
    v_mfma_f32_16x16x32_bf16 v[80:83], v[160:163], v[132:135], v[80:83]
    v_bitop3_b32 v250, v132, v134, v250 bitop3:0x80
    v_mfma_f32_16x16x32_bf16 v[84:87], v[164:167], v[132:135], v[84:87]
    ds_write_b128 v194, v[72:75] offset:192
    v_mfma_f32_16x16x32_bf16 v[80:83], v[220:223], v[136:139], v[80:83]
    v_bitop3_b32 v250, v136, v138, v250 bitop3:0x80
    v_mfma_f32_16x16x32_bf16 v[84:87], v[224:227], v[136:139], v[84:87]
    ds_write_b128 v194, v[76:79] offset:256
    v_mfma_f32_16x16x32_bf16 v[88:91], v[8:11], v[120:123], 0
    v_cmp_eq_u32 vcc, 0, v250
    v_mfma_f32_16x16x32_bf16 v[92:95], v[12:15], v[120:123], 0
    s_nop 1
    ds_write_b128 v194, v[80:83] offset:5376
    v_mfma_f32_16x16x32_bf16 v[88:91], v[28:31], v[124:127], v[88:91]
    v_mfma_f32_16x16x32_bf16 v[92:95], v[32:35], v[124:127], v[92:95]
    v_mfma_f32_16x16x32_bf16 v[88:91], v[48:51], v[128:131], v[88:91]
    v_mfma_f32_16x16x32_bf16 v[92:95], v[52:55], v[128:131], v[92:95]
    ds_write_b128 v194, v[84:87] offset:5440
    v_mfma_f32_16x16x32_bf16 v[88:91], v[168:171], v[132:135], v[88:91]
    v_mfma_f32_16x16x32_bf16 v[92:95], v[172:175], v[132:135], v[92:95]
    v_mfma_f32_16x16x32_bf16 v[88:91], v[228:231], v[136:139], v[88:91]
    v_mfma_f32_16x16x32_bf16 v[92:95], v[232:235], v[136:139], v[92:95]
    v_mfma_f32_16x16x32_bf16 v[96:99], v[16:19], v[120:123], 0
    v_mfma_f32_16x16x32_bf16 v[96:99], v[36:39], v[124:127], v[96:99]
    s_nop 4
    ds_write_b128 v194, v[88:91] offset:5504
    v_mfma_f32_16x16x32_bf16 v[96:99], v[56:59], v[128:131], v[96:99]
    v_mfma_f32_16x16x32_bf16 v[96:99], v[176:179], v[132:135], v[96:99]
    ds_write_b128 v194, v[92:95] offset:5568
    v_mfma_f32_16x16x32_bf16 v[96:99], v[236:239], v[136:139], v[96:99]
    s_cbranch_vccnz Lredo_47
    s_nop 6
    ds_write_b128 v194, v[96:99] offset:5632
    v_mov_b32 v248, 160796
    v_mov_b32 v249, 1
    s_mov_b64 exec, 1
    ds_add_u32 v248, v249
    s_mov_b64 exec, -1
    s_branch LC_second
LC_split:
    v_mov_b32 v195, 1
    s_mov_b64 exec, 65280
    buffer_load_dword v195, v192, s[40:43], s78 offen offset:496 sc1
    s_mov_b64 exec, -1
Lgrp_50:
    s_waitcnt vmcnt(10)
    v_mfma_f32_16x16x32_bf16 v[60:63], v[0:3], v[100:103], 0
    v_bitop3_b32 v250, v100, v102, 1 bitop3:0x80
    v_mfma_f32_16x16x32_bf16 v[64:67], v[4:7], v[100:103], 0
    v_mfma_f32_16x16x32_bf16 v[68:71], v[8:11], v[100:103], 0
    v_mfma_f32_16x16x32_bf16 v[72:75], v[12:15], v[100:103], 0
    v_mfma_f32_16x16x32_bf16 v[76:79], v[16:19], v[100:103], 0
    s_waitcnt vmcnt(9)
    v_mfma_f32_16x16x32_bf16 v[60:63], v[20:23], v[104:107], v[60:63]
    v_bitop3_b32 v250, v104, v106, v250 bitop3:0x80
    v_mfma_f32_16x16x32_bf16 v[64:67], v[24:27], v[104:107], v[64:67]
    v_mfma_f32_16x16x32_bf16 v[68:71], v[28:31], v[104:107], v[68:71]
    v_mfma_f32_16x16x32_bf16 v[72:75], v[32:35], v[104:107], v[72:75]
    v_mfma_f32_16x16x32_bf16 v[76:79], v[36:39], v[104:107], v[76:79]
    s_waitcnt vmcnt(8)
    v_mfma_f32_16x16x32_bf16 v[60:63], v[40:43], v[108:111], v[60:63]
    v_bitop3_b32 v250, v108, v110, v250 bitop3:0x80
    v_mfma_f32_16x16x32_bf16 v[64:67], v[44:47], v[108:111], v[64:67]
    v_mfma_f32_16x16x32_bf16 v[68:71], v[48:51], v[108:111], v[68:71]
    v_mfma_f32_16x16x32_bf16 v[72:75], v[52:55], v[108:111], v[72:75]
    v_mfma_f32_16x16x32_bf16 v[76:79], v[56:59], v[108:111], v[76:79]
    s_waitcnt vmcnt(7)
    v_mfma_f32_16x16x32_bf16 v[60:63], v[160:163], v[112:115], v[60:63]
    v_bitop3_b32 v250, v112, v114, v250 bitop3:0x80
    v_mfma_f32_16x16x32_bf16 v[64:67], v[164:167], v[112:115], v[64:67]
    v_mfma_f32_16x16x32_bf16 v[68:71], v[168:171], v[112:115], v[68:71]
    v_mfma_f32_16x16x32_bf16 v[72:75], v[172:175], v[112:115], v[72:75]
    v_mfma_f32_16x16x32_bf16 v[76:79], v[176:179], v[112:115], v[76:79]
    s_waitcnt vmcnt(6)
    v_mfma_f32_16x16x32_bf16 v[60:63], v[220:223], v[116:119], v[60:63]
    v_bitop3_b32 v250, v116, v118, v250 bitop3:0x80
    v_mfma_f32_16x16x32_bf16 v[64:67], v[224:227], v[116:119], v[64:67]
    v_mfma_f32_16x16x32_bf16 v[68:71], v[228:231], v[116:119], v[68:71]
    v_cmp_eq_u32 vcc, 0, v250
    v_mfma_f32_16x16x32_bf16 v[72:75], v[232:235], v[116:119], v[72:75]
    v_mfma_f32_16x16x32_bf16 v[76:79], v[236:239], v[116:119], v[76:79]
    s_cbranch_vccnz Lredo_49
Lgrp_52:
    s_waitcnt vmcnt(1)
    v_mfma_f32_16x16x32_bf16 v[80:83], v[0:3], v[120:123], 0
    v_bitop3_b32 v250, v120, v122, 1 bitop3:0x80
    v_mfma_f32_16x16x32_bf16 v[84:87], v[4:7], v[120:123], 0
    ds_write_b128 v194, v[60:63] offset:0
    v_mfma_f32_16x16x32_bf16 v[80:83], v[20:23], v[124:127], v[80:83]
    v_bitop3_b32 v250, v124, v126, v250 bitop3:0x80
    v_mfma_f32_16x16x32_bf16 v[84:87], v[24:27], v[124:127], v[84:87]
    ds_write_b128 v194, v[64:67] offset:64
    v_mfma_f32_16x16x32_bf16 v[80:83], v[40:43], v[128:131], v[80:83]
    v_bitop3_b32 v250, v128, v130, v250 bitop3:0x80
    v_mfma_f32_16x16x32_bf16 v[84:87], v[44:47], v[128:131], v[84:87]
    ds_write_b128 v194, v[68:71] offset:128
    v_mfma_f32_16x16x32_bf16 v[80:83], v[160:163], v[132:135], v[80:83]
    v_bitop3_b32 v250, v132, v134, v250 bitop3:0x80
    v_mfma_f32_16x16x32_bf16 v[84:87], v[164:167], v[132:135], v[84:87]
    ds_write_b128 v194, v[72:75] offset:192
    v_mfma_f32_16x16x32_bf16 v[80:83], v[220:223], v[136:139], v[80:83]
    v_bitop3_b32 v250, v136, v138, v250 bitop3:0x80
    v_mfma_f32_16x16x32_bf16 v[84:87], v[224:227], v[136:139], v[84:87]
    ds_write_b128 v194, v[76:79] offset:256
    v_mfma_f32_16x16x32_bf16 v[88:91], v[8:11], v[120:123], 0
    v_cmp_eq_u32 vcc, 0, v250
    v_mfma_f32_16x16x32_bf16 v[92:95], v[12:15], v[120:123], 0
    s_nop 1
    ds_write_b128 v194, v[80:83] offset:5376
    v_mfma_f32_16x16x32_bf16 v[88:91], v[28:31], v[124:127], v[88:91]
    v_mfma_f32_16x16x32_bf16 v[92:95], v[32:35], v[124:127], v[92:95]
    v_mfma_f32_16x16x32_bf16 v[88:91], v[48:51], v[128:131], v[88:91]
    v_mfma_f32_16x16x32_bf16 v[92:95], v[52:55], v[128:131], v[92:95]
    ds_write_b128 v194, v[84:87] offset:5440
    v_mfma_f32_16x16x32_bf16 v[88:91], v[168:171], v[132:135], v[88:91]
    v_mfma_f32_16x16x32_bf16 v[92:95], v[172:175], v[132:135], v[92:95]
    v_mfma_f32_16x16x32_bf16 v[88:91], v[228:231], v[136:139], v[88:91]
    v_mfma_f32_16x16x32_bf16 v[92:95], v[232:235], v[136:139], v[92:95]
    v_mfma_f32_16x16x32_bf16 v[96:99], v[16:19], v[120:123], 0
    v_mfma_f32_16x16x32_bf16 v[96:99], v[36:39], v[124:127], v[96:99]
    s_nop 4
    ds_write_b128 v194, v[88:91] offset:5504
    v_mfma_f32_16x16x32_bf16 v[96:99], v[56:59], v[128:131], v[96:99]
    v_mfma_f32_16x16x32_bf16 v[96:99], v[176:179], v[132:135], v[96:99]
    ds_write_b128 v194, v[92:95] offset:5568
    v_mfma_f32_16x16x32_bf16 v[96:99], v[236:239], v[136:139], v[96:99]
    s_cbranch_vccnz Lredo_51
    s_nop 6
    ds_write_b128 v194, v[96:99] offset:5632
    s_waitcnt vmcnt(0)
    v_and_b32 v195, 1, v195
    v_cmp_eq_u32 vcc, 0, v195
    v_mov_b32 v248, 160796
    v_mov_b32 v249, 1
    s_mov_b64 exec, 1
    ds_add_u32 v248, v249
    s_mov_b64 exec, -1
    s_cbranch_vccz LC_go
    s_mov_b64 exec, 65280
    s_mov_b32 s83, 0
Lpoll_53:
    buffer_load_dword v195, v192, s[40:43], s78 offen offset:496 sc1
    s_add_u32 s83, s83, 1
    s_waitcnt vmcnt(0)
    v_and_b32 v195, 1, v195
    v_cmp_eq_u32 vcc, 0, v195
    s_cbranch_vccz Lpd_54
    s_cmp_lt_u32 s83, 200000
    s_cbranch_scc1 Lpoll_53
Lpd_54:
    s_mov_b64 exec, -1
LC_go:
    buffer_load_dwordx4 v[140:143], v191, s[40:43], s73 offen offset:0 sc1
    buffer_load_dwordx4 v[144:147], v191, s[40:43], s74 offen offset:0 sc1
    buffer_load_dwordx4 v[148:151], v191, s[40:43], s75 offen offset:0 sc1
    buffer_load_dwordx4 v[152:155], v191, s[40:43], s76 offen offset:0 sc1
    buffer_load_dwordx4 v[156:159], v191, s[40:43], s77 offen offset:0 sc1
    buffer_load_dwordx4 v[180:183], v191, s[40:43], s73 offen offset:256 sc1
    buffer_load_dwordx4 v[184:187], v191, s[40:43], s74 offen offset:256 sc1
    buffer_load_dwordx4 v[216:219], v191, s[40:43], s75 offen offset:256 sc1
    buffer_load_dwordx4 v[240:243], v191, s[40:43], s76 offen offset:256 sc1
    buffer_load_dwordx4 v[244:247], v191, s[40:43], s77 offen offset:256 sc1
    v_mov_b32 v248, 160792
    v_mov_b32 v249, 1
    s_mov_b64 exec, 1
    ds_add_u32 v248, v249
    s_mov_b64 exec, -1
LC_second:
Lgrp_56:
    s_waitcnt vmcnt(9)
    v_mfma_f32_16x16x32_bf16 v[60:63], v[0:3], v[140:143], 0
    v_bitop3_b32 v250, v140, v142, 1 bitop3:0x80
    v_mfma_f32_16x16x32_bf16 v[64:67], v[4:7], v[140:143], 0
    v_mfma_f32_16x16x32_bf16 v[68:71], v[8:11], v[140:143], 0
    v_mfma_f32_16x16x32_bf16 v[72:75], v[12:15], v[140:143], 0
    v_mfma_f32_16x16x32_bf16 v[76:79], v[16:19], v[140:143], 0
    s_waitcnt vmcnt(8)
    v_mfma_f32_16x16x32_bf16 v[60:63], v[20:23], v[144:147], v[60:63]
    v_bitop3_b32 v250, v144, v146, v250 bitop3:0x80
    v_mfma_f32_16x16x32_bf16 v[64:67], v[24:27], v[144:147], v[64:67]
    v_mfma_f32_16x16x32_bf16 v[68:71], v[28:31], v[144:147], v[68:71]
    v_mfma_f32_16x16x32_bf16 v[72:75], v[32:35], v[144:147], v[72:75]
    v_mfma_f32_16x16x32_bf16 v[76:79], v[36:39], v[144:147], v[76:79]
    s_waitcnt vmcnt(7)
    v_mfma_f32_16x16x32_bf16 v[60:63], v[40:43], v[148:151], v[60:63]
    v_bitop3_b32 v250, v148, v150, v250 bitop3:0x80
    v_mfma_f32_16x16x32_bf16 v[64:67], v[44:47], v[148:151], v[64:67]
    v_mfma_f32_16x16x32_bf16 v[68:71], v[48:51], v[148:151], v[68:71]
    v_mfma_f32_16x16x32_bf16 v[72:75], v[52:55], v[148:151], v[72:75]
    v_mfma_f32_16x16x32_bf16 v[76:79], v[56:59], v[148:151], v[76:79]
    s_waitcnt vmcnt(6)
    v_mfma_f32_16x16x32_bf16 v[60:63], v[160:163], v[152:155], v[60:63]
    v_bitop3_b32 v250, v152, v154, v250 bitop3:0x80
    v_mfma_f32_16x16x32_bf16 v[64:67], v[164:167], v[152:155], v[64:67]
    v_mfma_f32_16x16x32_bf16 v[68:71], v[168:171], v[152:155], v[68:71]
    v_mfma_f32_16x16x32_bf16 v[72:75], v[172:175], v[152:155], v[72:75]
    v_mfma_f32_16x16x32_bf16 v[76:79], v[176:179], v[152:155], v[76:79]
    s_waitcnt vmcnt(5)
    v_mfma_f32_16x16x32_bf16 v[60:63], v[220:223], v[156:159], v[60:63]
    v_bitop3_b32 v250, v156, v158, v250 bitop3:0x80
    v_mfma_f32_16x16x32_bf16 v[64:67], v[224:227], v[156:159], v[64:67]
    v_mfma_f32_16x16x32_bf16 v[68:71], v[228:231], v[156:159], v[68:71]
    v_cmp_eq_u32 vcc, 0, v250
    v_mfma_f32_16x16x32_bf16 v[72:75], v[232:235], v[156:159], v[72:75]
    v_mfma_f32_16x16x32_bf16 v[76:79], v[236:239], v[156:159], v[76:79]
    s_cbranch_vccnz Lredo_55
Lgrp_58:
    s_waitcnt vmcnt(0)
    v_mfma_f32_16x16x32_bf16 v[80:83], v[0:3], v[180:183], 0
    v_bitop3_b32 v250, v180, v182, 1 bitop3:0x80
    v_mfma_f32_16x16x32_bf16 v[84:87], v[4:7], v[180:183], 0
    ds_write_b128 v194, v[60:63] offset:10752
    v_mfma_f32_16x16x32_bf16 v[80:83], v[20:23], v[184:187], v[80:83]
    v_bitop3_b32 v250, v184, v186, v250 bitop3:0x80
    v_mfma_f32_16x16x32_bf16 v[84:87], v[24:27], v[184:187], v[84:87]
    ds_write_b128 v194, v[64:67] offset:10816
    v_mfma_f32_16x16x32_bf16 v[80:83], v[40:43], v[216:219], v[80:83]
    v_bitop3_b32 v250, v216, v218, v250 bitop3:0x80
    v_mfma_f32_16x16x32_bf16 v[84:87], v[44:47], v[216:219], v[84:87]
    ds_write_b128 v194, v[68:71] offset:10880
    v_mfma_f32_16x16x32_bf16 v[80:83], v[160:163], v[240:243], v[80:83]
    v_bitop3_b32 v250, v240, v242, v250 bitop3:0x80
    v_mfma_f32_16x16x32_bf16 v[84:87], v[164:167], v[240:243], v[84:87]
    ds_write_b128 v194, v[72:75] offset:10944
    v_mfma_f32_16x16x32_bf16 v[80:83], v[220:223], v[244:247], v[80:83]
    v_bitop3_b32 v250, v244, v246, v250 bitop3:0x80
    v_mfma_f32_16x16x32_bf16 v[84:87], v[224:227], v[244:247], v[84:87]
    ds_write_b128 v194, v[76:79] offset:11008
    v_mfma_f32_16x16x32_bf16 v[88:91], v[8:11], v[180:183], 0
    v_cmp_eq_u32 vcc, 0, v250
    v_mfma_f32_16x16x32_bf16 v[92:95], v[12:15], v[180:183], 0
    s_nop 1
    ds_write_b128 v194, v[80:83] offset:16128
    v_mfma_f32_16x16x32_bf16 v[88:91], v[28:31], v[184:187], v[88:91]
    v_mfma_f32_16x16x32_bf16 v[92:95], v[32:35], v[184:187], v[92:95]
    v_mfma_f32_16x16x32_bf16 v[88:91], v[48:51], v[216:219], v[88:91]
    v_mfma_f32_16x16x32_bf16 v[92:95], v[52:55], v[216:219], v[92:95]
    ds_write_b128 v194, v[84:87] offset:16192
    v_mfma_f32_16x16x32_bf16 v[88:91], v[168:171], v[240:243], v[88:91]
    v_mfma_f32_16x16x32_bf16 v[92:95], v[172:175], v[240:243], v[92:95]
    v_mfma_f32_16x16x32_bf16 v[88:91], v[228:231], v[244:247], v[88:91]
    v_mfma_f32_16x16x32_bf16 v[92:95], v[232:235], v[244:247], v[92:95]
    v_mfma_f32_16x16x32_bf16 v[96:99], v[16:19], v[180:183], 0
    v_mfma_f32_16x16x32_bf16 v[96:99], v[36:39], v[184:187], v[96:99]
    s_nop 4
    ds_write_b128 v194, v[88:91] offset:16256
    v_mfma_f32_16x16x32_bf16 v[96:99], v[56:59], v[216:219], v[96:99]
    v_mfma_f32_16x16x32_bf16 v[96:99], v[176:179], v[240:243], v[96:99]
    ds_write_b128 v194, v[92:95] offset:16320
    v_mfma_f32_16x16x32_bf16 v[96:99], v[236:239], v[244:247], v[96:99]
    s_cbranch_vccnz Lredo_57
    s_nop 6
    ds_write_b128 v194, v[96:99] offset:16384
    v_mov_b32 v248, 160800
    v_mov_b32 v249, 1
    s_mov_b64 exec, 1
    ds_add_u32 v248, v249
    s_mov_b64 exec, -1
    v_mov_b32 v248, 160800
    s_mov_b32 s83, 0
Lspin_59:
    ds_read_b32 v249, v248
    s_add_u32 s83, s83, 1
    s_waitcnt lgkmcnt(0)
    v_readfirstlane_b32 s82, v249
    s_cmp_gt_u32 s83, 1600000
    s_cbranch_scc1 Lspd_60
    s_cmp_lt_u32 s82, 4
    s_cbranch_scc1 Lspin_59
Lspd_60:
LC_join:
    s_xor_b32 s1, s53, 0
    s_lshl2_add_u32 s0, s1, s52
    ds_read_b128 v[100:103], v198 offset:0
    ds_read_b128 v[104:107], v198 offset:16
    ds_read_b64 v[108:109], v199 offset:256
    ds_read_b128 v[110:113], v198 offset:21504
    ds_read_b128 v[114:117], v198 offset:21520
    ds_read_b64 v[118:119], v199 offset:21760
    ds_read_b128 v[120:123], v198 offset:43008
    ds_read_b128 v[124:127], v198 offset:43024
    ds_read_b64 v[128:129], v199 offset:43264
    ds_read_b128 v[130:133], v198 offset:64512
    ds_read_b128 v[134:137], v198 offset:64528
    ds_read_b64 v[138:139], v199 offset:64768
    v_lshlrev_b32 v0, 16, v210
    v_and_b32 v1, 0xffff0000, v210
    v_lshlrev_b32 v2, 16, v211
    v_and_b32 v3, 0xffff0000, v211
    v_lshlrev_b32 v4, 16, v212
    v_and_b32 v5, 0xffff0000, v212
    v_lshlrev_b32 v6, 16, v213
    v_and_b32 v7, 0xffff0000, v213
    v_lshlrev_b32 v8, 16, v214
    v_and_b32 v9, 0xffff0000, v214
    s_lshl_b32 s77, s7, 10
    s_add_u32 s77, s77, s62
    s_lshl_b32 s3, s49, 7
    s_add_u32 s76, s77, s3
    v_mov_b32 v19, s6
    v_lshlrev_b32 v26, 1, v255
    v_and_b32 v27, 7, v255
    v_lshrrev_b32 v28, 3, v255
    v_lshlrev_b32 v29, 4, v28
    v_lshl_add_u32 v27, v27, 7, v29
    s_add_u32 s70, s77, 262144
    s_waitcnt lgkmcnt(9)
    v_pk_add_f32 v[0:1], v[0:1], v[100:101]
    v_pk_add_f32 v[2:3], v[2:3], v[102:103]
    v_pk_add_f32 v[4:5], v[4:5], v[104:105]
    v_pk_add_f32 v[6:7], v[6:7], v[106:107]
    v_pk_add_f32 v[8:9], v[8:9], v[108:109]
    s_waitcnt lgkmcnt(6)
    v_pk_add_f32 v[0:1], v[0:1], v[110:111]
    v_pk_add_f32 v[2:3], v[2:3], v[112:113]
    v_pk_add_f32 v[4:5], v[4:5], v[114:115]
    v_pk_add_f32 v[6:7], v[6:7], v[116:117]
    v_pk_add_f32 v[8:9], v[8:9], v[118:119]
    s_waitcnt lgkmcnt(3)
    v_pk_add_f32 v[0:1], v[0:1], v[120:121]
    v_pk_add_f32 v[2:3], v[2:3], v[122:123]
    v_pk_add_f32 v[4:5], v[4:5], v[124:125]
    v_pk_add_f32 v[6:7], v[6:7], v[126:127]
    v_pk_add_f32 v[8:9], v[8:9], v[128:129]
    s_waitcnt lgkmcnt(0)
    v_pk_add_f32 v[0:1], v[0:1], v[130:131]
    v_pk_add_f32 v[2:3], v[2:3], v[132:133]
    v_pk_add_f32 v[4:5], v[4:5], v[134:135]
    v_pk_add_f32 v[6:7], v[6:7], v[136:137]
    v_pk_add_f32 v[8:9], v[8:9], v[138:139]
    v_pk_add_f32 v[100:101], v[0:1], v[2:3]
    v_pk_mul_f32 v[102:103], v[0:1], v[0:1]
    v_pk_mul_f32 v[104:105], v[0:1], v[200:201]
    v_pk_fma_f32 v[102:103], v[2:3], v[2:3], v[102:103]
    v_pk_fma_f32 v[104:105], v[2:3], v[202:203], v[104:105]
    v_pk_add_f32 v[100:101], v[100:101], v[4:5]
    v_pk_fma_f32 v[102:103], v[4:5], v[4:5], v[102:103]
    v_pk_fma_f32 v[104:105], v[4:5], v[204:205], v[104:105]
    v_pk_add_f32 v[100:101], v[100:101], v[6:7]
    v_pk_fma_f32 v[102:103], v[6:7], v[6:7], v[102:103]
    v_pk_fma_f32 v[104:105], v[6:7], v[206:207], v[104:105]
    v_pk_add_f32 v[100:101], v[100:101], v[8:9]
    v_pk_fma_f32 v[102:103], v[8:9], v[8:9], v[102:103]
    v_pk_fma_f32 v[104:105], v[8:9], v[208:209], v[104:105]
    v_add_f32 v16, v100, v101
    v_add_f32 v17, v102, v103
    v_add_f32 v18, v104, v105
    v_add_f32_dpp v16, v16, v16 quad_perm:[1,0,3,2] row_mask:0xf bank_mask:0xf
    v_add_f32_dpp v17, v17, v17 quad_perm:[1,0,3,2] row_mask:0xf bank_mask:0xf
    v_add_f32_dpp v18, v18, v18 quad_perm:[1,0,3,2] row_mask:0xf bank_mask:0xf
    v_add_f32_dpp v16, v16, v16 quad_perm:[2,3,0,1] row_mask:0xf bank_mask:0xf
    v_add_f32_dpp v17, v17, v17 quad_perm:[2,3,0,1] row_mask:0xf bank_mask:0xf
    v_add_f32_dpp v18, v18, v18 quad_perm:[2,3,0,1] row_mask:0xf bank_mask:0xf
    v_add_f32_dpp v16, v16, v16 row_half_mirror row_mask:0xf bank_mask:0xf
    v_add_f32_dpp v17, v17, v17 row_half_mirror row_mask:0xf bank_mask:0xf
    v_add_f32_dpp v18, v18, v18 row_half_mirror row_mask:0xf bank_mask:0xf
    s_mov_b32 exec_lo, 0x1010101
    s_mov_b32 exec_hi, 0x1010101
    s_add_u32 s3, s76, 262144
    buffer_store_dwordx4 v[16:19], v26, s[40:43], s3 offen
    s_mov_b64 exec, -1
    s_setprio 0
    v_cvt_pk_bf16_f32 v160, v0, v1
    v_cvt_pk_bf16_f32 v161, v2, v3
    v_cvt_pk_bf16_f32 v162, v4, v5
    v_cvt_pk_bf16_f32 v163, v6, v7
    v_cvt_pk_bf16_f32 v164, v8, v9
    v_lshlrev_b32 v0, 16, v160
    v_and_b32 v1, 0xffff0000, v160
    v_lshlrev_b32 v2, 16, v161
    v_and_b32 v3, 0xffff0000, v161
    v_lshlrev_b32 v4, 16, v162
    v_and_b32 v5, 0xffff0000, v162
    v_lshlrev_b32 v6, 16, v163
    v_and_b32 v7, 0xffff0000, v163
    v_lshlrev_b32 v8, 16, v164
    v_and_b32 v9, 0xffff0000, v164
    s_lshl_b32 s3, s0, 5
    s_add_u32 s3, s3, 161024
    v_lshl_add_u32 v30, v28, 2, s3
    s_lshl_b32 s3, s1, 5
    s_add_u32 s3, s3, s48
    s_lshl2_add_u32 s3, s3, s52
    s_lshl_b32 s3, s3, 3
    v_add_u32 v28, s3, v28
    v_mov_b32 v36, 0xfffff800
    v_lshlrev_b32 v31, 4, v255
    v_add_u32 v32, 161024, v31
    v_lshlrev_b32 v33, 2, v255
    v_add_u32 v33, 161024, v33
    s_and_b32 s3, s48, 7
    s_xor_b32 s3, s3, s49
    s_or_b32 s68, s3, s7
    s_lshl_b32 s69, s48, 8
    s_add_u32 s69, s69, 622592
    s_mov_b32 s83, 0
LC_lp:
    buffer_load_dwordx4 v[20:23], v27, s[40:43], s70 offen sc1
    s_add_u32 s83, s83, 1
    s_waitcnt vmcnt(0)
    v_cmp_ne_u32 vcc, s6, v23
    s_cbranch_vccz LC_lok
    s_cmp_lt_u32 s83, 12
    s_cbranch_scc1 LC_lp
    s_branch LC_lslow
LC_lok:
    v_add_f32_dpp v20, v20, v20 quad_perm:[1,0,3,2] row_mask:0xf bank_mask:0xf
    v_add_f32_dpp v21, v21, v21 quad_perm:[1,0,3,2] row_mask:0xf bank_mask:0xf
    v_add_f32_dpp v22, v22, v22 quad_perm:[1,0,3,2] row_mask:0xf bank_mask:0xf
    v_add_f32_dpp v20, v20, v20 quad_perm:[2,3,0,1] row_mask:0xf bank_mask:0xf
    v_add_f32_dpp v21, v21, v21 quad_perm:[2,3,0,1] row_mask:0xf bank_mask:0xf
    v_add_f32_dpp v22, v22, v22 quad_perm:[2,3,0,1] row_mask:0xf bank_mask:0xf
    v_add_f32_dpp v20, v20, v20 row_half_mirror row_mask:0xf bank_mask:0xf
    v_add_f32_dpp v21, v21, v21 row_half_mirror row_mask:0xf bank_mask:0xf
    v_add_f32_dpp v22, v22, v22 row_half_mirror row_mask:0xf bank_mask:0xf
    v_mul_f32 v20, 0x3acccccd, v20
    v_mul_f32 v21, 0x3acccccd, v21
    v_fma_f32 v21, -v20, v20, v21
    v_max_f32 v21, 0, v21
    v_add_f32 v12, 0x3727c5ac, v21
    v_rsq_f32 v12, v12
    v_fma_f32 v14, -v20, s56, v22
    v_mul_f32 v14, v14, v12
    v_ashrrev_i32 v15, 31, v14
    v_or_b32 v15, 0x80000000, v15
    v_xor_b32 v15, v15, v14
    v_and_or_b32 v165, v15, v36, v28
    ds_write_b32 v30, v165
    s_waitcnt lgkmcnt(0)
    s_barrier
    s_cmp_lg_u32 s68, 0
    s_cbranch_scc1 LC_nopub
    s_mov_b64 exec, 0xffff
    ds_read_b128 v[40:43], v32
    s_waitcnt lgkmcnt(0)
    v_lshrrev_b32 v44, 21, v43
    v_bfe_u32 v45, v43, 11, 10
    v_and_or_b32 v40, v40, v36, v44
    v_and_or_b32 v41, v41, v36, v45
    v_mov_b32 v43, s6
    buffer_store_dwordx4 v[40:43], v31, s[40:43], s69 offen sc1
    s_mov_b64 exec, -1
LC_nopub:
    s_mov_b32 exec_lo, 0x1010101
    s_mov_b32 exec_hi, 0x1010101
    buffer_store_dwordx4 v[16:19], v26, s[40:43], s76 offen sc1
    s_mov_b64 exec, -1
    ds_read_b32 v34, v33
    s_cmp_lg_u32 s50, 0
    s_cbranch_scc1 Lge_61
    v_lshrrev_b32 v46, 1, v255
    v_and_b32 v47, 1, v255
    v_mul_u32_u24 v46, 3456, v46
    v_lshl_add_u32 v46, v47, 4, v46
    v_mov_b32 v47, v46
    s_mov_b32 exec_lo, 0
    v_mov_b32 v47, 0x7fffffff
    s_mov_b64 exec, -1
    s_mul_i32 s5, s7, 7168
    s_mul_i32 s4, s7, 276480
    s_lshl_b32 s3, s51, 5
    s_add_u32 s4, s4, s3
    s_add_u32 s3, s4, 0
    s_add_u32 s3, s4, 110592
    s_add_u32 s3, s4, 221184
    s_add_u32 m0, s5, 5120
    s_nop 0
    buffer_load_dwordx4 v47, s[28:31], s3 offen lds
Lge_61:
    s_cmp_lg_u32 s50, 1
    s_cbranch_scc1 Lwe_62
    v_lshrrev_b32 v46, 1, v255
    v_and_b32 v47, 1, v255
    v_mul_u32_u24 v46, 1280, v46
    v_lshl_add_u32 v46, v47, 4, v46
    s_mul_i32 s5, s7, 7168
    s_mul_i32 s4, s7, 40960
    s_lshl_b32 s3, s51, 5
    s_add_u32 s4, s4, s3
    s_add_u32 m0, s5, 3072
    s_add_u32 s3, s4, 983040
    buffer_load_dwordx4 v46, s[32:35], s3 offen lds
    s_add_u32 m0, s5, 4096
    s_add_u32 s3, s4, 1310720
    buffer_load_dwordx4 v46, s[32:35], s3 offen lds
    s_add_u32 m0, s5, 5120
    s_add_u32 s3, s4, 1638400
    buffer_load_dwordx4 v46, s[32:35], s3 offen lds
Lwe_62:
    s_lshl_b32 s3, s7, 10
    v_add_u32 v31, s3, v31
    s_mov_b32 s76, 622592
    s_waitcnt lgkmcnt(0)
    v_max_u32_dpp v35, v34, v34 quad_perm:[1,0,3,2] row_mask:0xf bank_mask:0xf
    v_cvt_pk_bf16_f32 v21, v21, v21
    v_lshlrev_b32 v21, 16, v21
    v_max_u32_dpp v35, v35, v35 quad_perm:[2,3,0,1] row_mask:0xf bank_mask:0xf
    v_add_f32 v21, 0x3727c5ac, v21
    v_cvt_pk_bf16_f32 v21, v21, v21
    v_max_u32_dpp v35, v35, v35 row_half_mirror row_mask:0xf bank_mask:0xf
    v_lshlrev_b32 v21, 16, v21
    v_sqrt_f32 v21, v21
    v_max_u32_dpp v35, v35, v35 row_mirror row_mask:0xf bank_mask:0xf
    v_cvt_pk_bf16_f32 v13, v20, v20
    v_lshlrev_b32 v13, 16, v13
    v_max_u32_dpp v35, v35, v35 row_bcast:15 row_mask:0xa bank_mask:0xf
    v_cvt_pk_bf16_f32 v21, v21, v21
    v_lshlrev_b32 v21, 16, v21
    v_max_u32_dpp v35, v35, v35 row_bcast:31 row_mask:0xc bank_mask:0xf
    v_rcp_f32 v12, v21
    v_sub_f32 v100, v0, v13
    v_readlane_b32 s69, v35, 63
    v_sub_f32 v101, v1, v13
    v_sub_f32 v102, v2, v13
    v_cmp_ne_u32 vcc, s69, v34
    v_sub_f32 v103, v3, v13
    v_sub_f32 v104, v4, v13
    v_cndmask_b32 v34, 0, v34, vcc
    v_sub_f32 v105, v5, v13
    v_sub_f32 v106, v6, v13
    v_max_u32_dpp v35, v34, v34 quad_perm:[1,0,3,2] row_mask:0xf bank_mask:0xf
    v_sub_f32 v107, v7, v13
    v_sub_f32 v108, v8, v13
    v_max_u32_dpp v35, v35, v35 quad_perm:[2,3,0,1] row_mask:0xf bank_mask:0xf
    v_sub_f32 v109, v9, v13
    v_cvt_pk_bf16_f32 v110, v100, v101
    v_max_u32_dpp v35, v35, v35 row_half_mirror row_mask:0xf bank_mask:0xf
    v_cvt_pk_bf16_f32 v111, v102, v103
    v_cvt_pk_bf16_f32 v112, v104, v105
    v_max_u32_dpp v35, v35, v35 row_mirror row_mask:0xf bank_mask:0xf
    v_cvt_pk_bf16_f32 v113, v106, v107
    v_cvt_pk_bf16_f32 v114, v108, v109
    v_max_u32_dpp v35, v35, v35 row_bcast:15 row_mask:0xa bank_mask:0xf
    v_lshlrev_b32 v100, 16, v110
    v_and_b32 v101, 0xffff0000, v110
    v_max_u32_dpp v35, v35, v35 row_bcast:31 row_mask:0xc bank_mask:0xf
    v_lshlrev_b32 v102, 16, v111
    v_and_b32 v103, 0xffff0000, v111
    v_readlane_b32 s70, v35, 63
    v_lshlrev_b32 v104, 16, v112
    v_and_b32 v105, 0xffff0000, v112
    v_cmp_ne_u32 vcc, s70, v34
    v_lshlrev_b32 v106, 16, v113
    v_and_b32 v107, 0xffff0000, v113
    v_cndmask_b32 v34, 0, v34, vcc
    v_lshlrev_b32 v108, 16, v114
    v_and_b32 v109, 0xffff0000, v114
    v_max_u32_dpp v35, v34, v34 quad_perm:[1,0,3,2] row_mask:0xf bank_mask:0xf
    v_mul_f32 v100, v100, v12
    v_mul_f32 v101, v101, v12
    v_max_u32_dpp v35, v35, v35 quad_perm:[2,3,0,1] row_mask:0xf bank_mask:0xf
    v_mul_f32 v102, v102, v12
    v_mul_f32 v103, v103, v12
    v_max_u32_dpp v35, v35, v35 row_half_mirror row_mask:0xf bank_mask:0xf
    v_mul_f32 v104, v104, v12
    v_mul_f32 v105, v105, v12
    v_max_u32_dpp v35, v35, v35 row_mirror row_mask:0xf bank_mask:0xf
    v_mul_f32 v106, v106, v12
    v_mul_f32 v107, v107, v12
    v_max_u32_dpp v35, v35, v35 row_bcast:15 row_mask:0xa bank_mask:0xf
    v_mul_f32 v108, v108, v12
    v_mul_f32 v109, v109, v12
    v_max_u32_dpp v35, v35, v35 row_bcast:31 row_mask:0xc bank_mask:0xf
    v_cvt_pk_bf16_f32 v166, v100, v101
    v_cvt_pk_bf16_f32 v167, v102, v103
    v_readlane_b32 s71, v35, 63
    v_cvt_pk_bf16_f32 v168, v104, v105
    v_cvt_pk_bf16_f32 v169, v106, v107
    v_cmp_ne_u32 vcc, s71, v34
    v_cvt_pk_bf16_f32 v170, v108, v109
    v_lshlrev_b32 v100, 16, v166
    v_cndmask_b32 v34, 0, v34, vcc
    v_and_b32 v101, 0xffff0000, v166
    v_lshlrev_b32 v102, 16, v167
    v_and_b32 v103, 0xffff0000, v167
    v_lshlrev_b32 v104, 16, v168
    v_and_b32 v105, 0xffff0000, v168
    v_lshlrev_b32 v106, 16, v169
    v_and_b32 v107, 0xffff0000, v169
    v_lshlrev_b32 v108, 16, v170
    v_and_b32 v109, 0xffff0000, v170
    v_pk_add_f32 v[100:101], v[100:101], v[0:1]
    v_pk_add_f32 v[102:103], v[102:103], v[2:3]
    v_pk_add_f32 v[104:105], v[104:105], v[4:5]
    v_pk_add_f32 v[106:107], v[106:107], v[6:7]
    v_pk_add_f32 v[108:109], v[108:109], v[8:9]
    v_cvt_pk_bf16_f32 v172, v100, v101
    v_cvt_pk_bf16_f32 v173, v102, v103
    v_cvt_pk_bf16_f32 v174, v104, v105
    v_cvt_pk_bf16_f32 v175, v106, v107
    v_cvt_pk_bf16_f32 v176, v108, v109
    v_min_u32 v160, -2, v160
    v_min_u32 v161, -2, v161
    buffer_load_dwordx4 v[40:43], v31, s[40:43], s76 offen sc1
    v_min_u32 v162, -2, v162
    v_min_u32 v163, -2, v163
    v_min_u32 v164, -2, v164
    v_min_u32 v165, -2, v165
    v_min_u32 v166, -2, v166
    v_min_u32 v167, -2, v167
    v_min_u32 v168, -2, v168
    v_min_u32 v169, -2, v169
    v_min_u32 v170, -2, v170
    s_mov_b32 s4, 0x11111111
    s_mov_b32 s5, 0x11111111
    v_mov_b32_dpp v178, v170 quad_perm:[0,0,0,0] row_mask:0xf bank_mask:0xf
    v_mov_b32_dpp v179, v170 quad_perm:[1,1,1,1] row_mask:0xf bank_mask:0xf
    v_mov_b32_dpp v180, v170 quad_perm:[2,2,2,2] row_mask:0xf bank_mask:0xf
    v_mov_b32_dpp v181, v170 quad_perm:[3,3,3,3] row_mask:0xf bank_mask:0xf
    s_mov_b64 s[72:73], -1
    v_and_b32 v29, 8, v255
    v_lshrrev_b32 v37, 8, v31
    v_lshlrev_b32 v37, 5, v37
    v_lshl_add_u32 v37, v29, 7, v37
    v_and_b32 v38, 7, v255
    v_lshl_add_u32 v37, v38, 2, v37
    v_mov_b32 v38, 160832
    v_and_b32 v46, 7, v255
    v_lshlrev_b32 v39, 4, v46
    v_lshlrev_b32 v47, 3, v46
    v_lshlrev_b32 v48, 7, v46
    v_lshlrev_b32 v46, 5, v46
    s_waitcnt vmcnt(0)
    v_cmp_ne_u32 vcc, s6, v43
    s_cbranch_vccz LD_rok
    s_mov_b32 s83, 0
Lpoll_63:
    buffer_load_dwordx4 v[40:43], v31, s[40:43], s76 offen sc1
    s_add_u32 s83, s83, 1
    s_waitcnt vmcnt(0)
    v_cmp_ne_u32 vcc, s6, v43
    s_cbranch_vccz Lpd_64
    s_cmp_lt_u32 s83, 200000
    s_cbranch_scc1 Lpoll_63
Lpd_64:
LD_rok:
    v_lshlrev_b32 v43, 21, v40
    v_and_b32 v44, 0x3ff, v41
    v_lshl_or_b32 v43, v44, 11, v43
    v_add3_u32 v43, v43, v37, 3
    v_and_or_b32 v40, v40, v36, v37
    v_add_u32 v44, 1, v37
    v_and_or_b32 v41, v41, v36, v44
LD_rank:
    v_cmp_lt_u32 s[8:9], s69, v40
    v_cmp_lt_u32 s[10:11], s69, v41
    v_cmp_lt_u32 s[12:13], s69, v42
    v_cmp_lt_u32 s[14:15], s69, v43
    v_cmp_lt_u32 s[16:17], s70, v40
    v_cmp_lt_u32 s[18:19], s70, v41
    v_cmp_lt_u32 s[20:21], s70, v42
    v_cmp_lt_u32 s[22:23], s70, v43
    v_cmp_lt_u32 s[76:77], s71, v40
    v_cmp_lt_u32 s[78:79], s71, v41
    v_cmp_lt_u32 s[80:81], s71, v42
    v_cmp_lt_u32 s[74:75], s71, v43
    s_bcnt1_i32_b64 s8, s[8:9]
    s_bcnt1_i32_b64 s10, s[10:11]
    s_bcnt1_i32_b64 s12, s[12:13]
    s_bcnt1_i32_b64 s14, s[14:15]
    s_bcnt1_i32_b64 s16, s[16:17]
    s_bcnt1_i32_b64 s18, s[18:19]
    s_bcnt1_i32_b64 s20, s[20:21]
    s_bcnt1_i32_b64 s22, s[22:23]
    s_bcnt1_i32_b64 s76, s[76:77]
    s_bcnt1_i32_b64 s78, s[78:79]
    s_bcnt1_i32_b64 s80, s[80:81]
    s_bcnt1_i32_b64 s74, s[74:75]
    s_add_u32 s8, s8, s10
    s_add_u32 s12, s12, s14
    s_add_u32 s8, s8, s12
    s_min_u32 s8, s8, 8
    s_add_u32 s16, s16, s18
    s_add_u32 s20, s20, s22
    s_add_u32 s16, s16, s20
    s_min_u32 s16, s16, 8
    s_add_u32 s76, s76, s78
    s_add_u32 s80, s80, s74
    s_add_u32 s76, s76, s80
    s_min_u32 s76, s76, 8
    s_lshl_b32 s16, s16, 8
    s_pack_ll_b32_b16 s82, s8, s76
    s_or_b32 s82, s82, s16
    v_mov_b32 v44, s82
    s_mov_b64 exec, 1
    ds_add_u32 v38, v44
    s_mov_b64 exec, -1
    s_waitcnt lgkmcnt(0)
    s_barrier
    ds_read_b32 v44, v38
    s_waitcnt lgkmcnt(0)
    v_readfirstlane_b32 s82, v44
    s_bfe_u32 s76, s82, 0x80000
    s_cmp_ge_u32 s76, 8
    s_cbranch_scc1 LD_ranked
    s_bfe_u32 s3, s69, 0x20003
    s_bfe_u32 s77, s69, 0x1000a
    s_lshl2_add_u32 s3, s77, s3
    s_cmp_eq_u32 s3, s0
    s_cbranch_scc1 Lpush_65
Lpb_66:
    s_bfe_u32 s76, s82, 0x80008
    s_cmp_ge_u32 s76, 8
    s_cbranch_scc1 LD_ranked
    s_bfe_u32 s3, s70, 0x20003
    s_bfe_u32 s77, s70, 0x1000a
    s_lshl2_add_u32 s3, s77, s3
    s_cmp_eq_u32 s3, s0
    s_cbranch_scc1 Lpush_67
Lpb_68:
    s_bfe_u32 s76, s82, 0x80010
    s_cmp_ge_u32 s76, 8
    s_cbranch_scc1 LD_ranked
    s_bfe_u32 s3, s71, 0x20003
    s_bfe_u32 s77, s71, 0x1000a
    s_lshl2_add_u32 s3, s77, s3
    s_cmp_eq_u32 s3, s0
    s_cbranch_scc1 Lpush_69
Lpb_70:
    v_max_u32_dpp v35, v34, v34 quad_perm:[1,0,3,2] row_mask:0xf bank_mask:0xf
    s_nop 1
    v_max_u32_dpp v35, v35, v35 quad_perm:[2,3,0,1] row_mask:0xf bank_mask:0xf
    s_nop 1
    v_max_u32_dpp v35, v35, v35 row_half_mirror row_mask:0xf bank_mask:0xf
    s_nop 1
    v_max_u32_dpp v35, v35, v35 row_mirror row_mask:0xf bank_mask:0xf
    s_nop 1
    v_max_u32_dpp v35, v35, v35 row_bcast:15 row_mask:0xa bank_mask:0xf
    s_nop 1
    v_max_u32_dpp v35, v35, v35 row_bcast:31 row_mask:0xc bank_mask:0xf
    s_nop 0
    v_readlane_b32 s69, v35, 63
    s_nop 1
    v_cmp_ne_u32 vcc, s69, v34
    s_nop 1
    v_cndmask_b32 v34, 0, v34, vcc
    s_nop 1
    v_max_u32_dpp v35, v34, v34 quad_perm:[1,0,3,2] row_mask:0xf bank_mask:0xf
    s_nop 1
    v_max_u32_dpp v35, v35, v35 quad_perm:[2,3,0,1] row_mask:0xf bank_mask:0xf
    s_nop 1
    v_max_u32_dpp v35, v35, v35 row_half_mirror row_mask:0xf bank_mask:0xf
    s_nop 1
    v_max_u32_dpp v35, v35, v35 row_mirror row_mask:0xf bank_mask:0xf
    s_nop 1
    v_max_u32_dpp v35, v35, v35 row_bcast:15 row_mask:0xa bank_mask:0xf
    s_nop 1
    v_max_u32_dpp v35, v35, v35 row_bcast:31 row_mask:0xc bank_mask:0xf
    s_nop 0
    v_readlane_b32 s70, v35, 63
    s_nop 1
    v_cmp_ne_u32 vcc, s70, v34
    s_nop 1
    v_cndmask_b32 v34, 0, v34, vcc
    s_nop 1
    v_max_u32_dpp v35, v34, v34 quad_perm:[1,0,3,2] row_mask:0xf bank_mask:0xf
    s_nop 1
    v_max_u32_dpp v35, v35, v35 quad_perm:[2,3,0,1] row_mask:0xf bank_mask:0xf
    s_nop 1
    v_max_u32_dpp v35, v35, v35 row_half_mirror row_mask:0xf bank_mask:0xf
    s_nop 1
    v_max_u32_dpp v35, v35, v35 row_mirror row_mask:0xf bank_mask:0xf
    s_nop 1
    v_max_u32_dpp v35, v35, v35 row_bcast:15 row_mask:0xa bank_mask:0xf
    s_nop 1
    v_max_u32_dpp v35, v35, v35 row_bcast:31 row_mask:0xc bank_mask:0xf
    s_nop 0
    v_readlane_b32 s71, v35, 63
    s_nop 1
    v_cmp_ne_u32 vcc, s71, v34
    s_nop 1
    v_cndmask_b32 v34, 0, v34, vcc
    v_add_u32 v38, 4, v38
    s_branch LD_rank
Lpush_65:
    s_and_b32 s3, s69, 7
    s_lshl_b32 s3, s3, 3
    s_lshl_b64 s[78:79], 0xff, s3
    s_lshl3_add_u32 s3, s49, s76
    s_lshl_b32 s3, s3, 8
    s_add_u32 s3, s3, 589824
    s_add_u32 s77, s3, 16384
    s_mul_i32 s3, s49, 80
    s_add_u32 s3, s3, s76
    s_lshl_b32 s3, s3, 4
    s_add_u32 s3, s3, 589824
    s_mov_b64 exec, s[78:79]
    buffer_store_dwordx4 v[166:169], v48, s[40:43], s3 offen sc1
    s_and_b64 exec, exec, s[4:5]
    buffer_store_dwordx4 v[178:181], v46, s[40:43], s3 offen offset:1024 sc1
    s_mov_b64 exec, s[78:79]
    buffer_store_dwordx4 v[160:163], v39, s[40:43], s77 offen sc1
    buffer_store_dwordx2 v[164:165], v47, s[40:43], s77 offen offset:128 sc1
    s_andn2_b64 s[72:73], s[72:73], s[78:79]
    s_mov_b64 exec, -1
    s_branch Lpb_66
Lpush_67:
    s_and_b32 s3, s70, 7
    s_lshl_b32 s3, s3, 3
    s_lshl_b64 s[78:79], 0xff, s3
    s_lshl3_add_u32 s3, s49, s76
    s_lshl_b32 s3, s3, 8
    s_add_u32 s3, s3, 589824
    s_add_u32 s77, s3, 16384
    s_mul_i32 s3, s49, 80
    s_add_u32 s3, s3, s76
    s_lshl_b32 s3, s3, 4
    s_add_u32 s3, s3, 589824
    s_mov_b64 exec, s[78:79]
    buffer_store_dwordx4 v[166:169], v48, s[40:43], s3 offen sc1
    s_and_b64 exec, exec, s[4:5]
    buffer_store_dwordx4 v[178:181], v46, s[40:43], s3 offen offset:1024 sc1
    s_mov_b64 exec, s[78:79]
    buffer_store_dwordx4 v[160:163], v39, s[40:43], s77 offen sc1
    buffer_store_dwordx2 v[164:165], v47, s[40:43], s77 offen offset:128 sc1
    s_andn2_b64 s[72:73], s[72:73], s[78:79]
    s_mov_b64 exec, -1
    s_branch Lpb_68
Lpush_69:
    s_and_b32 s3, s71, 7
    s_lshl_b32 s3, s3, 3
    s_lshl_b64 s[78:79], 0xff, s3
    s_lshl3_add_u32 s3, s49, s76
    s_lshl_b32 s3, s3, 8
    s_add_u32 s3, s3, 589824
    s_add_u32 s77, s3, 16384
    s_mul_i32 s3, s49, 80
    s_add_u32 s3, s3, s76
    s_lshl_b32 s3, s3, 4
    s_add_u32 s3, s3, 589824
    s_mov_b64 exec, s[78:79]
    buffer_store_dwordx4 v[166:169], v48, s[40:43], s3 offen sc1
    s_and_b64 exec, exec, s[4:5]
    buffer_store_dwordx4 v[178:181], v46, s[40:43], s3 offen offset:1024 sc1
    s_mov_b64 exec, s[78:79]
    buffer_store_dwordx4 v[160:163], v39, s[40:43], s77 offen sc1
    buffer_store_dwordx2 v[164:165], v47, s[40:43], s77 offen offset:128 sc1
    s_andn2_b64 s[72:73], s[72:73], s[78:79]
    s_mov_b64 exec, -1
    s_branch Lpb_70
LD_ranked:
    s_cmp_eq_u32 s50, 2
    s_cbranch_scc1 LD_outn
    v_lshrrev_b32 v20, 4, v255
    v_and_b32 v36, 7, v255
    v_lshrrev_b32 v37, 3, v255
    v_mul_u32_u24 v60, 1536, v20
    v_mul_u32_u24 v61, 48, v36
    v_add_u32 v60, v60, v61
    v_mul_u32_u24 v61, 48, v37
    s_lshl_b32 s3, s7, 2
    s_add_u32 s3, s3, 61440
    v_add_u32 v60, s3, v60
    s_cmp_eq_u32 s50, 1
    s_cbranch_scc1 LD_down
    v_lshlrev_b32 v23, 4, v36
    v_lshl_add_u32 v21, v20, 7, v23
    v_and_b32 v22, 8, v255
    v_lshl_add_u32 v21, v22, 6, v21
    v_min_u32 v22, 1, v20
    v_lshl_add_u32 v22, v22, 7, v23
    s_mul_i32 s76, s7, 1280
    s_add_u32 s76, s76, 589824
    s_and_b32 s3, s7, 1
    s_mul_i32 s3, s3, 3072
    s_add_u32 s3, s3, 61440
    v_mul_u32_u24 v62, 384, v36
    v_add3_u32 v62, v62, v61, s3
    v_lshlrev_b32 v63, 1, v255
    s_lshl1_add_u32 s77, s51, s7
    s_lshl_b32 s77, s77, 7
    s_add_u32 s77, s77, 655360
    v_lshrrev_b32 v46, 4, v255
    v_bfe_u32 v47, v255, 2, 2
    v_lshl_add_u32 v46, v46, 3, v47
    v_lshlrev_b32 v46, 5, v46
    v_and_b32 v47, 3, v255
    v_lshl_add_u32 v46, v47, 3, v46
    s_mul_i32 s3, s7, 7168
    v_add_u32 v46, s3, v46
    ds_read_b64_tr_b16 v[220:221], v46 offset:0
    ds_read_b64_tr_b16 v[222:223], v46 offset:128
    ds_read_b64_tr_b16 v[224:225], v46 offset:1024
    ds_read_b64_tr_b16 v[226:227], v46 offset:1152
    ds_read_b64_tr_b16 v[228:229], v46 offset:2048
    ds_read_b64_tr_b16 v[230:231], v46 offset:2176
    ds_read_b64_tr_b16 v[232:233], v46 offset:3072
    ds_read_b64_tr_b16 v[234:235], v46 offset:3200
    ds_read_b64_tr_b16 v[236:237], v46 offset:4096
    ds_read_b64_tr_b16 v[238:239], v46 offset:4224
    ds_read_b64_tr_b16 v[240:241], v46 offset:5120
    ds_read_b64_tr_b16 v[242:243], v46 offset:5248
    ds_read_b64_tr_b16 v[244:245], v46 offset:6144
    ds_read_b64_tr_b16 v[246:247], v46 offset:6272
    s_sleep 9
    s_mov_b32 s83, 0
Lpoll_71:
    buffer_load_dwordx4 v[84:87], v21, s[40:43], s76 offen sc1
    buffer_load_dwordx4 v[88:91], v22, s[40:43], s76 offen offset:1024 sc1
    s_add_u32 s83, s83, 1
    s_waitcnt vmcnt(0)
    v_max3_u32 v96, v84, v85, v86
    v_max3_u32 v96, v96, v87, v88
    v_max3_u32 v96, v96, v89, v90
    v_max_u32 v96, v96, v91
    v_cmp_eq_u32 vcc, -1, v96
    s_cbranch_vccz Lpd_72
    s_cmp_lt_u32 s83, 200000
    s_cbranch_scc1 Lpoll_71
Lpd_72:
LD_xsok:
    s_waitcnt lgkmcnt(0)
    v_mfma_f32_16x16x32_bf16 v[132:135], v[224:227], v[84:87], 0
    v_mfma_f32_16x16x32_bf16 v[136:139], v[236:239], v[84:87], 0
    v_mfma_f32_16x16x32_bf16 v[124:127], v[220:223], v[84:87], 0
    v_mfma_f32_16x16x32_bf16 v[128:131], v[232:235], v[84:87], 0
    v_mfma_f32_16x16x32_bf16 v[124:127], v[228:231], v[88:91], v[124:127]
    v_mfma_f32_16x16x32_bf16 v[128:131], v[240:243], v[88:91], v[128:131]
    s_nop 6
    v_add_f32_dpp v124, v132, v124 row_ror:8 row_mask:0xf bank_mask:0xf
    v_add_f32_dpp v125, v133, v125 row_ror:8 row_mask:0xf bank_mask:0xf
    v_add_f32_dpp v126, v134, v126 row_ror:8 row_mask:0xf bank_mask:0xf
    v_add_f32_dpp v127, v135, v127 row_ror:8 row_mask:0xf bank_mask:0xf
    v_add_f32_dpp v128, v136, v128 row_ror:8 row_mask:0xf bank_mask:0xf
    v_add_f32_dpp v129, v137, v129 row_ror:8 row_mask:0xf bank_mask:0xf
    v_add_f32_dpp v130, v138, v130 row_ror:8 row_mask:0xf bank_mask:0xf
    v_add_f32_dpp v131, v139, v131 row_ror:8 row_mask:0xf bank_mask:0xf
    s_mov_b32 exec_lo, 0xff00ff
    s_mov_b32 exec_hi, 0xff00ff
    ds_write_b32 v60, v124 offset:0
    ds_write_b32 v60, v125 offset:384
    ds_write_b32 v60, v126 offset:768
    ds_write_b32 v60, v127 offset:1152
    ds_write_b32 v60, v128 offset:6144
    ds_write_b32 v60, v129 offset:6528
    ds_write_b32 v60, v130 offset:6912
    ds_write_b32 v60, v131 offset:7296
    s_mov_b64 exec, -1
    s_waitcnt lgkmcnt(0)
    s_barrier
    s_cmp_ge_u32 s7, 2
    s_cbranch_scc1 LD_out2
    ds_read_b128 v[64:67], v62 offset:0
    ds_read_b128 v[68:71], v62 offset:16
    ds_read_b128 v[72:75], v62 offset:6144
    ds_read_b128 v[76:79], v62 offset:6160
    s_waitcnt lgkmcnt(2)
    v_pk_add_f32 v[64:65], v[64:65], v[68:69]
    v_pk_add_f32 v[66:67], v[66:67], v[70:71]
    v_pk_add_f32 v[64:65], v[64:65], v[66:67]
    v_add_f32 v80, v64, v65
    s_waitcnt lgkmcnt(0)
    v_mul_f32 v82, 0xbfb8aa3b, v80
    v_pk_add_f32 v[72:73], v[72:73], v[76:77]
    v_exp_f32 v82, v82
    v_pk_add_f32 v[74:75], v[74:75], v[78:79]
    v_add_f32 v82, 1.0, v82
    v_pk_add_f32 v[72:73], v[72:73], v[74:75]
    v_rcp_f32 v82, v82
    v_add_f32 v81, v72, v73
    v_mul_f32 v81, v81, v80
    v_mul_f32 v82, v82, v81
    s_nop 1
    v_mov_b32_dpp v83, v82 quad_perm:[1,0,3,2] row_mask:0xf bank_mask:0xf
    v_cvt_pk_bf16_f32 v82, v82, v83
    v_min_u32 v82, -2, v82
    s_nop 1
    v_mov_b32_dpp v83, v82 row_shl:2 row_mask:0xf bank_mask:0xf
    v_mov_b32_dpp v84, v82 row_shl:4 row_mask:0xf bank_mask:0xf
    v_mov_b32_dpp v85, v82 row_shl:6 row_mask:0xf bank_mask:0xf
    s_mov_b32 exec_lo, 0x1010101
    s_mov_b32 exec_hi, 0x1010101
    buffer_store_dwordx4 v[82:85], v63, s[40:43], s77 offen sc1
    s_mov_b64 exec, -1
LD_out2:
    s_barrier
LD_out:
    v_mov_b32_dpp v178, v176 quad_perm:[0,0,0,0] row_mask:0xf bank_mask:0xf
    v_mov_b32_dpp v179, v176 quad_perm:[1,1,1,1] row_mask:0xf bank_mask:0xf
    v_mov_b32_dpp v180, v176 quad_perm:[2,2,2,2] row_mask:0xf bank_mask:0xf
    v_mov_b32_dpp v181, v176 quad_perm:[3,3,3,3] row_mask:0xf bank_mask:0xf
    s_mov_b64 exec, s[72:73]
    buffer_store_dwordx4 v[172:175], v196, s[36:39], s61 offen
    s_and_b32 exec_lo, s72, 0x11111111
    s_and_b32 exec_hi, s73, 0x11111111
    buffer_store_dwordx4 v[178:181], v197, s[36:39], s61 offen offset:128
    s_mov_b64 exec, -1
    s_branch Lfin
LD_outn:
    v_mov_b32_dpp v178, v176 quad_perm:[0,0,0,0] row_mask:0xf bank_mask:0xf
    v_mov_b32_dpp v179, v176 quad_perm:[1,1,1,1] row_mask:0xf bank_mask:0xf
    v_mov_b32_dpp v180, v176 quad_perm:[2,2,2,2] row_mask:0xf bank_mask:0xf
    v_mov_b32_dpp v181, v176 quad_perm:[3,3,3,3] row_mask:0xf bank_mask:0xf
    s_mov_b64 exec, s[72:73]
    buffer_store_dwordx4 v[172:175], v196, s[36:39], s61 offen nt
    s_and_b32 exec_lo, s72, 0x11111111
    s_and_b32 exec_hi, s73, 0x11111111
    buffer_store_dwordx4 v[178:181], v197, s[36:39], s61 offen offset:128 nt
    s_mov_b64 exec, -1
    s_branch Lfin
LD_down:
    s_cmp_lg_u32 s50, 1
    s_cbranch_scc1 Lwe_75
    v_lshrrev_b32 v46, 1, v255
    v_and_b32 v47, 1, v255
    v_mul_u32_u24 v46, 1280, v46
    v_lshl_add_u32 v46, v47, 4, v46
    s_mul_i32 s5, s7, 7168
    s_mul_i32 s4, s7, 40960
    s_lshl_b32 s3, s51, 5
    s_add_u32 s4, s4, s3
    s_add_u32 m0, s5, 6144
    s_add_u32 s3, s4, 1966080
    buffer_load_dwordx4 v46, s[32:35], s3 offen lds
Lwe_75:
    s_lshl_b32 s80, s51, 5
    s_mul_i32 s3, s51, 13108
    s_lshr_b32 s3, s3, 16
    s_lshl_b32 s78, s3, 11
    s_add_u32 s78, s78, 589824
    s_mul_i32 s3, s3, 160
    s_sub_u32 s3, s80, s3
    s_add_u32 s79, s78, s3
    s_add_u32 s77, s79, 16384
    v_lshlrev_b32 v56, 8, v37
    v_lshl_add_u32 v57, v36, 2, v56
    s_lshl_b32 s79, s51, 8
    s_add_u32 s79, s79, 589824
    v_lshrrev_b32 v57, 2, v36
    v_lshlrev_b32 v57, 7, v57
    v_lshl_add_u32 v57, v37, 4, v57
    v_and_b32 v55, 3, v36
    v_lshl_add_u32 v57, v55, 2, v57
    s_cmp_eq_u32 s3, 128
    s_cselect_b32 s3, 3, 2
    v_lshlrev_b32 v55, s3, v36
    v_add_u32 v55, v55, v56
    s_add_u32 s78, s78, 16384
    v_lshlrev_b32 v54, 7, v20
    v_lshl_add_u32 v54, v36, 4, v54
    v_and_b32 v59, 8, v255
    v_lshl_add_u32 v59, v59, 9, v54
    s_lshl_b32 s81, s7, 9
    s_add_u32 s81, s81, 655360
    s_min_u32 s82, s7, 5
    s_lshl_b32 s82, s82, 9
    s_add_u32 s82, s82, 679936
    v_mul_u32_u24 v62, 768, v36
    v_add_u32 v62, v62, v61
    v_add_u32 v62, 61440, v62
    s_sleep 4
    s_mov_b32 s83, 0
Lpoll_76:
    buffer_load_dword v84, v57, s[40:43], s79 offen sc1
    buffer_load_dword v85, v55, s[40:43], s77 offen sc1
    buffer_load_dword v86, v56, s[40:43], s78 offen offset:132 sc1
    s_add_u32 s83, s83, 1
    s_waitcnt vmcnt(0)
    v_max3_u32 v96, v84, v85, v86
    v_cmp_eq_u32 vcc, -1, v96
    s_cbranch_vccz Lpd_77
    s_cmp_lt_u32 s83, 200000
    s_cbranch_scc1 Lpoll_76
Lpd_77:
    v_and_b32 v98, 0xfffff800, v86
    v_ashrrev_i32 v97, 31, v98
    v_not_b32 v97, v97
    v_or_b32 v97, 0x80000000, v97
    v_xor_b32 v98, v98, v97
    v_cvt_pk_bf16_f32 v98, v98, v98
    v_lshlrev_b32 v98, 16, v98
    v_mul_f32 v98, 0xbfb8aa3b, v98
    v_exp_f32 v98, v98
    s_nop 0
    v_add_f32 v98, 1.0, v98
    v_rcp_f32 v98, v98
    s_nop 0
    v_cvt_pk_bf16_f32 v98, v98, v98
    v_lshlrev_b32 v98, 16, v98
    v_and_b32 v58, 0x7ff, v86
    v_mul_u32_u24 v58, 1280, v58
    v_lshl_add_u32 v58, v36, 2, v58
    v_lshlrev_b32 v88, 16, v84
    v_and_b32 v89, 0xffff0000, v84
    v_lshlrev_b32 v86, 16, v85
    v_and_b32 v87, 0xffff0000, v85
    v_add_f32 v88, v88, v86
    v_add_f32 v89, v89, v87
    v_mov_b32_dpp v178, v176 quad_perm:[0,0,0,0] row_mask:0xf bank_mask:0xf
    v_mov_b32_dpp v179, v176 quad_perm:[1,1,1,1] row_mask:0xf bank_mask:0xf
    v_mov_b32_dpp v180, v176 quad_perm:[2,2,2,2] row_mask:0xf bank_mask:0xf
    v_mov_b32_dpp v181, v176 quad_perm:[3,3,3,3] row_mask:0xf bank_mask:0xf
    s_mov_b64 exec, s[72:73]
    buffer_store_dwordx4 v[172:175], v196, s[36:39], s61 offen nt
    s_and_b32 exec_lo, s72, 0x11111111
    s_and_b32 exec_hi, s73, 0x11111111
    buffer_store_dwordx4 v[178:181], v197, s[36:39], s61 offen offset:128 nt
    s_mov_b64 exec, -1
    v_lshrrev_b32 v46, 4, v255
    v_bfe_u32 v47, v255, 2, 2
    v_lshl_add_u32 v46, v46, 3, v47
    v_lshlrev_b32 v46, 5, v46
    v_and_b32 v47, 3, v255
    v_lshl_add_u32 v46, v47, 3, v46
    s_mul_i32 s3, s7, 7168
    v_add_u32 v46, s3, v46
    ds_read_b64_tr_b16 v[220:221], v46 offset:0
    ds_read_b64_tr_b16 v[222:223], v46 offset:128
    ds_read_b64_tr_b16 v[224:225], v46 offset:1024
    ds_read_b64_tr_b16 v[226:227], v46 offset:1152
    ds_read_b64_tr_b16 v[228:229], v46 offset:2048
    ds_read_b64_tr_b16 v[230:231], v46 offset:2176
    ds_read_b64_tr_b16 v[232:233], v46 offset:3072
    ds_read_b64_tr_b16 v[234:235], v46 offset:3200
    ds_read_b64_tr_b16 v[236:237], v46 offset:4096
    ds_read_b64_tr_b16 v[238:239], v46 offset:4224
    ds_read_b64_tr_b16 v[240:241], v46 offset:5120
    ds_read_b64_tr_b16 v[242:243], v46 offset:5248
    ds_read_b64_tr_b16 v[244:245], v46 offset:6144
    ds_read_b64_tr_b16 v[246:247], v46 offset:6272
    s_waitcnt lgkmcnt(0)
    s_sleep 19
    s_add_u32 s76, s81, 8192
    s_add_u32 s77, s81, 16384
    s_mov_b32 s83, 0
Lpoll_79:
    buffer_load_dwordx4 v[100:103], v59, s[40:43], s81 offen sc1
    buffer_load_dwordx4 v[104:107], v59, s[40:43], s76 offen sc1
    buffer_load_dwordx4 v[108:111], v59, s[40:43], s77 offen sc1
    buffer_load_dwordx4 v[112:115], v54, s[40:43], s82 offen sc1
    s_add_u32 s83, s83, 1
    s_waitcnt vmcnt(0)
    v_max3_u32 v128, v100, v101, v102
    v_max3_u32 v128, v128, v103, v104
    v_max3_u32 v128, v128, v105, v106
    v_max3_u32 v128, v128, v107, v108
    v_max3_u32 v128, v128, v109, v110
    v_max3_u32 v128, v128, v111, v112
    v_max3_u32 v128, v128, v113, v114
    v_max_u32 v128, v128, v115
    v_cmp_eq_u32 vcc, -1, v128
    s_cbranch_vccz Lpd_80
    s_cmp_lt_u32 s83, 200000
    s_cbranch_scc1 Lpoll_79
Lpd_80:
    v_mfma_f32_16x16x32_bf16 v[136:139], v[224:227], v[100:103], 0
    v_mfma_f32_16x16x32_bf16 v[132:135], v[220:223], v[100:103], 0
    v_mfma_f32_16x16x32_bf16 v[136:139], v[232:235], v[104:107], v[136:139]
    v_mfma_f32_16x16x32_bf16 v[132:135], v[228:231], v[104:107], v[132:135]
    v_mfma_f32_16x16x32_bf16 v[136:139], v[240:243], v[108:111], v[136:139]
    v_mfma_f32_16x16x32_bf16 v[132:135], v[236:239], v[108:111], v[132:135]
    v_mfma_f32_16x16x32_bf16 v[132:135], v[244:247], v[112:115], v[132:135]
    s_nop 7
    v_add_f32_dpp v132, v136, v132 row_ror:8 row_mask:0xf bank_mask:0xf
    v_add_f32_dpp v133, v137, v133 row_ror:8 row_mask:0xf bank_mask:0xf
    v_add_f32_dpp v134, v138, v134 row_ror:8 row_mask:0xf bank_mask:0xf
    v_add_f32_dpp v135, v139, v135 row_ror:8 row_mask:0xf bank_mask:0xf
    s_mov_b32 exec_lo, 0xff00ff
    s_mov_b32 exec_hi, 0xff00ff
    ds_write_b32 v60, v132 offset:0
    ds_write_b32 v60, v133 offset:384
    ds_write_b32 v60, v134 offset:768
    ds_write_b32 v60, v135 offset:1152
    s_mov_b64 exec, -1
    s_waitcnt lgkmcnt(0)
    s_barrier
    s_cmp_lg_u32 s7, 0
    s_cbranch_scc1 Lfin
    ds_read_b128 v[64:67], v62 offset:0
    ds_read_b128 v[68:71], v62 offset:16
    ds_read_b128 v[72:75], v62 offset:384
    ds_read_b128 v[76:79], v62 offset:400
    s_waitcnt lgkmcnt(2)
    v_pk_add_f32 v[64:65], v[64:65], v[68:69]
    v_pk_add_f32 v[66:67], v[66:67], v[70:71]
    v_pk_add_f32 v[64:65], v[64:65], v[66:67]
    v_add_f32 v80, v64, v65
    s_waitcnt lgkmcnt(0)
    v_pk_add_f32 v[72:73], v[72:73], v[76:77]
    v_pk_add_f32 v[74:75], v[74:75], v[78:79]
    v_pk_add_f32 v[72:73], v[72:73], v[74:75]
    v_add_f32 v81, v72, v73
    v_fma_f32 v80, v80, v98, v88
    v_fma_f32 v81, v81, v98, v89
    v_cvt_pk_bf16_f32 v82, v80, v81
    buffer_store_dword v82, v58, s[36:39], s80 offen
    s_cmp_lg_u32 s51, 0
    s_cbranch_scc1 Lfin
    s_mov_b32 s3, 0
    v_mov_b32 v1, s6
    s_mov_b64 exec, 1
    buffer_store_dword v1, off, s[40:43], s3 sc1
    s_mov_b64 exec, -1
    s_branch Lfin
LC_lslow:
    v_lshrrev_b32 v24, 3, v255
    v_and_b32 v25, 7, v255
    v_lshlrev_b32 v25, 4, v25
    v_lshl_add_u32 v24, v24, 10, v25
    s_lshl_b32 s70, s49, 7
    s_add_u32 s70, s70, s62
    s_add_u32 s71, s70, 262144
    s_mov_b32 s83, 0
Lpoll_81:
    buffer_load_dwordx4 v[20:23], v24, s[40:43], s71 offen sc1
    s_waitcnt vmcnt(0)
    v_cmp_eq_u32 vcc, s6, v23
    s_mov_b64 exec, vcc
    s_cbranch_execz Lfw_83
    buffer_store_dwordx4 v[20:23], v24, s[40:43], s70 offen sc1
Lfw_83:
    s_mov_b64 exec, -1
    s_waitcnt vmcnt(0)
    buffer_load_dwordx4 v[20:23], v27, s[40:43], s77 offen sc1
    s_add_u32 s83, s83, 1
    s_waitcnt vmcnt(0)
    v_cmp_ne_u32 vcc, s6, v23
    s_cbranch_vccz Lpd_82
    s_cmp_lt_u32 s83, 200000
    s_cbranch_scc1 Lpoll_81
Lpd_82:
    s_branch LC_lok
    s_branch Lfin
LC_X:
    v_mov_b32 v1, 160780
    s_mov_b32 s83, 0
Lspin_84:
    s_sleep 1
    ds_read_b32 v2, v1
    s_add_u32 s83, s83, 1
    s_waitcnt lgkmcnt(0)
    v_readfirstlane_b32 s82, v2
    s_cmp_gt_u32 s83, 1600000
    s_cbranch_scc1 Lspd_85
    s_cmp_lt_u32 s82, 8
    s_cbranch_scc1 Lspin_84
Lspd_85:
    s_waitcnt vmcnt(0)
    v_lshlrev_b32 v200, 16, v112
    v_and_b32 v201, 0xffff0000, v112
    v_lshlrev_b32 v202, 16, v113
    v_and_b32 v203, 0xffff0000, v113
    v_lshlrev_b32 v204, 16, v114
    v_and_b32 v205, 0xffff0000, v114
    v_lshlrev_b32 v206, 16, v115
    v_and_b32 v207, 0xffff0000, v115
    v_lshlrev_b32 v208, 16, v116
    v_and_b32 v209, 0xffff0000, v116
    v_lshlrev_b32 v130, 16, v118
    v_and_b32 v131, 0xffff0000, v118
    v_lshlrev_b32 v132, 16, v119
    v_and_b32 v133, 0xffff0000, v119
    v_lshlrev_b32 v134, 16, v120
    v_and_b32 v135, 0xffff0000, v120
    v_lshlrev_b32 v136, 16, v121
    v_and_b32 v137, 0xffff0000, v121
    v_lshlrev_b32 v138, 16, v122
    v_and_b32 v139, 0xffff0000, v122
    v_lshlrev_b32 v140, 16, v123
    v_and_b32 v141, 0xffff0000, v123
    v_lshlrev_b32 v142, 16, v124
    v_and_b32 v143, 0xffff0000, v124
    v_lshlrev_b32 v144, 16, v125
    v_and_b32 v145, 0xffff0000, v125
    v_add_f32 v130, v130, v138
    v_add_f32 v131, v131, v139
    v_add_f32 v132, v132, v140
    v_add_f32 v133, v133, v141
    v_add_f32 v134, v134, v142
    v_add_f32 v135, v135, v143
    v_add_f32 v136, v136, v144
    v_add_f32 v137, v137, v145
    v_add_f32 v130, v130, v134
    v_add_f32 v131, v131, v135
    v_add_f32 v132, v132, v136
    v_add_f32 v133, v133, v137
    v_add_f32 v130, v130, v132
    v_add_f32 v131, v131, v133
    v_add_f32 v130, v130, v131
    s_nop 1
    v_add_f32_dpp v130, v130, v130 quad_perm:[1,0,3,2] row_mask:0xf bank_mask:0xf
    s_nop 1
    v_add_f32_dpp v130, v130, v130 quad_perm:[2,3,0,1] row_mask:0xf bank_mask:0xf
    s_nop 1
    v_add_f32_dpp v130, v130, v130 row_half_mirror row_mask:0xf bank_mask:0xf
    s_nop 1
    v_add_f32_dpp v130, v130, v130 row_mirror row_mask:0xf bank_mask:0xf
    v_mov_b32 v131, v130
    s_nop 1
    v_permlane16_swap_b32 v130, v131
    v_add_f32 v130, v130, v131
    v_mov_b32 v131, v130
    s_nop 1
    v_permlane32_swap_b32 v130, v131
    v_add_f32 v130, v130, v131
    s_nop 0
    v_readfirstlane_b32 s56, v130
    v_mov_b32 v1, 160792
    s_mov_b32 s83, 0
Lspin_86:
    s_sleep 1
    ds_read_b32 v2, v1
    s_add_u32 s83, s83, 1
    s_waitcnt lgkmcnt(0)
    v_readfirstlane_b32 s82, v2
    s_cmp_gt_u32 s83, 1600000
    s_cbranch_scc1 Lspd_87
    s_cmp_lt_u32 s82, 4
    s_cbranch_scc1 Lspin_86
Lspd_87:
    s_cmp_lg_u32 s50, 0
    s_cbranch_scc1 Lge_88
    v_lshrrev_b32 v1, 1, v255
    v_and_b32 v2, 1, v255
    v_mul_u32_u24 v1, 3456, v1
    v_lshl_add_u32 v1, v2, 4, v1
    v_mov_b32 v2, v1
    s_mov_b32 exec_lo, 0
    v_mov_b32 v2, 0x7fffffff
    s_mov_b64 exec, -1
    s_mul_i32 s5, s52, 7168
    s_mul_i32 s4, s52, 276480
    s_lshl_b32 s3, s51, 5
    s_add_u32 s4, s4, s3
    s_add_u32 s3, s4, 0
    s_add_u32 m0, s5, 0
    s_nop 0
    buffer_load_dwordx4 v1, s[24:27], s3 offen lds
    s_add_u32 m0, s5, 3072
    s_nop 0
    buffer_load_dwordx4 v1, s[28:31], s3 offen lds
    s_add_u32 s3, s4, 110592
    s_add_u32 m0, s5, 1024
    s_nop 0
    buffer_load_dwordx4 v1, s[24:27], s3 offen lds
    s_add_u32 m0, s5, 4096
    s_nop 0
    buffer_load_dwordx4 v1, s[28:31], s3 offen lds
    s_add_u32 s3, s4, 221184
    s_add_u32 m0, s5, 2048
    s_nop 0
    buffer_load_dwordx4 v2, s[24:27], s3 offen lds
    s_add_u32 s3, s4, 1105920
    s_add_u32 m0, s5, 28672
    s_nop 0
    buffer_load_dwordx4 v1, s[24:27], s3 offen lds
    s_add_u32 m0, s5, 31744
    s_nop 0
    buffer_load_dwordx4 v1, s[28:31], s3 offen lds
    s_add_u32 s3, s4, 1216512
    s_add_u32 m0, s5, 29696
    s_nop 0
    buffer_load_dwordx4 v1, s[24:27], s3 offen lds
    s_add_u32 m0, s5, 32768
    s_nop 0
    buffer_load_dwordx4 v1, s[28:31], s3 offen lds
    s_add_u32 s3, s4, 1327104
    s_add_u32 m0, s5, 30720
    s_nop 0
    buffer_load_dwordx4 v2, s[24:27], s3 offen lds
Lge_88:
    s_cmp_lg_u32 s50, 1
    s_cbranch_scc1 Lwe_89
    v_lshrrev_b32 v1, 1, v255
    v_and_b32 v2, 1, v255
    v_mul_u32_u24 v1, 1280, v1
    v_lshl_add_u32 v1, v2, 4, v1
    s_mul_i32 s5, s52, 7168
    s_mul_i32 s4, s52, 40960
    s_lshl_b32 s3, s51, 5
    s_add_u32 s4, s4, s3
    s_add_u32 m0, s5, 0
    s_add_u32 s3, s4, 0
    buffer_load_dwordx4 v1, s[32:35], s3 offen lds
    s_add_u32 m0, s5, 1024
    s_add_u32 s3, s4, 327680
    buffer_load_dwordx4 v1, s[32:35], s3 offen lds
    s_add_u32 m0, s5, 2048
    s_add_u32 s3, s4, 655360
    buffer_load_dwordx4 v1, s[32:35], s3 offen lds
    s_add_u32 m0, s5, 28672
    s_add_u32 s3, s4, 163840
    buffer_load_dwordx4 v1, s[32:35], s3 offen lds
    s_add_u32 m0, s5, 29696
    s_add_u32 s3, s4, 491520
    buffer_load_dwordx4 v1, s[32:35], s3 offen lds
    s_add_u32 m0, s5, 30720
    s_add_u32 s3, s4, 819200
    buffer_load_dwordx4 v1, s[32:35], s3 offen lds
Lwe_89:
    v_mov_b32 v248, 160796
    s_mov_b32 s83, 0
Lspin_90:
    s_sleep 1
    ds_read_b32 v249, v248
    s_add_u32 s83, s83, 1
    s_waitcnt lgkmcnt(0)
    v_readfirstlane_b32 s82, v249
    s_cmp_gt_u32 s83, 1600000
    s_cbranch_scc1 Lspd_91
    s_cmp_lt_u32 s82, 4
    s_cbranch_scc1 Lspin_90
Lspd_91:
    s_branch LC_join
    s_branch Lfin
Lredo_45:
    s_nop 7
    s_mov_b32 s83, 0
Lpoll_92:
    buffer_load_dwordx4 v[100:103], v191, s[40:43], s68 offen offset:0 sc1
    buffer_load_dwordx4 v[104:107], v191, s[40:43], s69 offen offset:0 sc1
    buffer_load_dwordx4 v[108:111], v191, s[40:43], s70 offen offset:0 sc1
    buffer_load_dwordx4 v[112:115], v191, s[40:43], s71 offen offset:0 sc1
    buffer_load_dwordx4 v[116:119], v191, s[40:43], s72 offen offset:0 sc1
    s_add_u32 s83, s83, 1
    s_waitcnt vmcnt(0)
    v_bitop3_b32 v250, v100, v102, 1 bitop3:0x80
    v_bitop3_b32 v250, v104, v106, v250 bitop3:0x80
    v_bitop3_b32 v250, v108, v110, v250 bitop3:0x80
    v_bitop3_b32 v250, v112, v114, v250 bitop3:0x80
    v_bitop3_b32 v250, v116, v118, v250 bitop3:0x80
    v_cmp_eq_u32 vcc, 0, v250
    s_cbranch_vccz Lpd_93
    s_cmp_lt_u32 s83, 200000
    s_cbranch_scc1 Lpoll_92
Lpd_93:
    s_cbranch_vccz Lgrp_46
    v_mov_b32 v100, 1
    v_mov_b32 v102, 1
    v_mov_b32 v104, 1
    v_mov_b32 v106, 1
    v_mov_b32 v108, 1
    v_mov_b32 v110, 1
    v_mov_b32 v112, 1
    v_mov_b32 v114, 1
    v_mov_b32 v116, 1
    v_mov_b32 v118, 1
    s_branch Lgrp_46
Lredo_47:
    s_nop 7
    s_mov_b32 s83, 0
Lpoll_94:
    buffer_load_dwordx4 v[120:123], v191, s[40:43], s68 offen offset:256 sc1
    buffer_load_dwordx4 v[124:127], v191, s[40:43], s69 offen offset:256 sc1
    buffer_load_dwordx4 v[128:131], v191, s[40:43], s70 offen offset:256 sc1
    buffer_load_dwordx4 v[132:135], v191, s[40:43], s71 offen offset:256 sc1
    buffer_load_dwordx4 v[136:139], v191, s[40:43], s72 offen offset:256 sc1
    s_add_u32 s83, s83, 1
    s_waitcnt vmcnt(0)
    v_bitop3_b32 v250, v120, v122, 1 bitop3:0x80
    v_bitop3_b32 v250, v124, v126, v250 bitop3:0x80
    v_bitop3_b32 v250, v128, v130, v250 bitop3:0x80
    v_bitop3_b32 v250, v132, v134, v250 bitop3:0x80
    v_bitop3_b32 v250, v136, v138, v250 bitop3:0x80
    v_cmp_eq_u32 vcc, 0, v250
    s_cbranch_vccz Lpd_95
    s_cmp_lt_u32 s83, 200000
    s_cbranch_scc1 Lpoll_94
Lpd_95:
    s_cbranch_vccz Lgrp_48
    v_mov_b32 v120, 1
    v_mov_b32 v122, 1
    v_mov_b32 v124, 1
    v_mov_b32 v126, 1
    v_mov_b32 v128, 1
    v_mov_b32 v130, 1
    v_mov_b32 v132, 1
    v_mov_b32 v134, 1
    v_mov_b32 v136, 1
    v_mov_b32 v138, 1
    s_branch Lgrp_48
Lredo_49:
    s_nop 7
    s_mov_b32 s83, 0
Lpoll_96:
    buffer_load_dwordx4 v[100:103], v191, s[40:43], s68 offen offset:0 sc1
    buffer_load_dwordx4 v[104:107], v191, s[40:43], s69 offen offset:0 sc1
    buffer_load_dwordx4 v[108:111], v191, s[40:43], s70 offen offset:0 sc1
    buffer_load_dwordx4 v[112:115], v191, s[40:43], s71 offen offset:0 sc1
    buffer_load_dwordx4 v[116:119], v191, s[40:43], s72 offen offset:0 sc1
    s_add_u32 s83, s83, 1
    s_waitcnt vmcnt(0)
    v_bitop3_b32 v250, v100, v102, 1 bitop3:0x80
    v_bitop3_b32 v250, v104, v106, v250 bitop3:0x80
    v_bitop3_b32 v250, v108, v110, v250 bitop3:0x80
    v_bitop3_b32 v250, v112, v114, v250 bitop3:0x80
    v_bitop3_b32 v250, v116, v118, v250 bitop3:0x80
    v_cmp_eq_u32 vcc, 0, v250
    s_cbranch_vccz Lpd_97
    s_cmp_lt_u32 s83, 200000
    s_cbranch_scc1 Lpoll_96
Lpd_97:
    s_cbranch_vccz Lgrp_50
    v_mov_b32 v100, 1
    v_mov_b32 v102, 1
    v_mov_b32 v104, 1
    v_mov_b32 v106, 1
    v_mov_b32 v108, 1
    v_mov_b32 v110, 1
    v_mov_b32 v112, 1
    v_mov_b32 v114, 1
    v_mov_b32 v116, 1
    v_mov_b32 v118, 1
    s_branch Lgrp_50
Lredo_51:
    s_nop 7
    s_mov_b32 s83, 0
Lpoll_98:
    buffer_load_dwordx4 v[120:123], v191, s[40:43], s68 offen offset:256 sc1
    buffer_load_dwordx4 v[124:127], v191, s[40:43], s69 offen offset:256 sc1
    buffer_load_dwordx4 v[128:131], v191, s[40:43], s70 offen offset:256 sc1
    buffer_load_dwordx4 v[132:135], v191, s[40:43], s71 offen offset:256 sc1
    buffer_load_dwordx4 v[136:139], v191, s[40:43], s72 offen offset:256 sc1
    s_add_u32 s83, s83, 1
    s_waitcnt vmcnt(0)
    v_bitop3_b32 v250, v120, v122, 1 bitop3:0x80
    v_bitop3_b32 v250, v124, v126, v250 bitop3:0x80
    v_bitop3_b32 v250, v128, v130, v250 bitop3:0x80
    v_bitop3_b32 v250, v132, v134, v250 bitop3:0x80
    v_bitop3_b32 v250, v136, v138, v250 bitop3:0x80
    v_cmp_eq_u32 vcc, 0, v250
    s_cbranch_vccz Lpd_99
    s_cmp_lt_u32 s83, 200000
    s_cbranch_scc1 Lpoll_98
Lpd_99:
    s_cbranch_vccz Lgrp_52
    v_mov_b32 v120, 1
    v_mov_b32 v122, 1
    v_mov_b32 v124, 1
    v_mov_b32 v126, 1
    v_mov_b32 v128, 1
    v_mov_b32 v130, 1
    v_mov_b32 v132, 1
    v_mov_b32 v134, 1
    v_mov_b32 v136, 1
    v_mov_b32 v138, 1
    s_branch Lgrp_52
Lredo_55:
    s_nop 7
    s_mov_b32 s83, 0
Lpoll_100:
    buffer_load_dwordx4 v[140:143], v191, s[40:43], s73 offen offset:0 sc1
    buffer_load_dwordx4 v[144:147], v191, s[40:43], s74 offen offset:0 sc1
    buffer_load_dwordx4 v[148:151], v191, s[40:43], s75 offen offset:0 sc1
    buffer_load_dwordx4 v[152:155], v191, s[40:43], s76 offen offset:0 sc1
    buffer_load_dwordx4 v[156:159], v191, s[40:43], s77 offen offset:0 sc1
    s_add_u32 s83, s83, 1
    s_waitcnt vmcnt(0)
    v_bitop3_b32 v250, v140, v142, 1 bitop3:0x80
    v_bitop3_b32 v250, v144, v146, v250 bitop3:0x80
    v_bitop3_b32 v250, v148, v150, v250 bitop3:0x80
    v_bitop3_b32 v250, v152, v154, v250 bitop3:0x80
    v_bitop3_b32 v250, v156, v158, v250 bitop3:0x80
    v_cmp_eq_u32 vcc, 0, v250
    s_cbranch_vccz Lpd_101
    s_cmp_lt_u32 s83, 200000
    s_cbranch_scc1 Lpoll_100
Lpd_101:
    s_cbranch_vccz Lgrp_56
    v_mov_b32 v140, 1
    v_mov_b32 v142, 1
    v_mov_b32 v144, 1
    v_mov_b32 v146, 1
    v_mov_b32 v148, 1
    v_mov_b32 v150, 1
    v_mov_b32 v152, 1
    v_mov_b32 v154, 1
    v_mov_b32 v156, 1
    v_mov_b32 v158, 1
    s_branch Lgrp_56
Lredo_57:
    s_nop 7
    s_mov_b32 s83, 0
Lpoll_102:
    buffer_load_dwordx4 v[180:183], v191, s[40:43], s73 offen offset:256 sc1
    buffer_load_dwordx4 v[184:187], v191, s[40:43], s74 offen offset:256 sc1
    buffer_load_dwordx4 v[216:219], v191, s[40:43], s75 offen offset:256 sc1
    buffer_load_dwordx4 v[240:243], v191, s[40:43], s76 offen offset:256 sc1
    buffer_load_dwordx4 v[244:247], v191, s[40:43], s77 offen offset:256 sc1
    s_add_u32 s83, s83, 1
    s_waitcnt vmcnt(0)
    v_bitop3_b32 v250, v180, v182, 1 bitop3:0x80
    v_bitop3_b32 v250, v184, v186, v250 bitop3:0x80
    v_bitop3_b32 v250, v216, v218, v250 bitop3:0x80
    v_bitop3_b32 v250, v240, v242, v250 bitop3:0x80
    v_bitop3_b32 v250, v244, v246, v250 bitop3:0x80
    v_cmp_eq_u32 vcc, 0, v250
    s_cbranch_vccz Lpd_103
    s_cmp_lt_u32 s83, 200000
    s_cbranch_scc1 Lpoll_102
Lpd_103:
    s_cbranch_vccz Lgrp_58
    v_mov_b32 v180, 1
    v_mov_b32 v182, 1
    v_mov_b32 v184, 1
    v_mov_b32 v186, 1
    v_mov_b32 v216, 1
    v_mov_b32 v218, 1
    v_mov_b32 v240, 1
    v_mov_b32 v242, 1
    v_mov_b32 v244, 1
    v_mov_b32 v246, 1
    s_branch Lgrp_58
    s_branch Lfin
Linv_11:
    s_nop 7
    v_mov_b32 v48, 0xff800000
    v_mov_b32 v49, 0xff800000
    v_mov_b32 v50, 0xff800000
    v_mov_b32 v51, 0xff800000
    v_mov_b32 v52, 0xff800000
    v_mov_b32 v53, 0xff800000
    v_mov_b32 v54, 0xff800000
    v_mov_b32 v55, 0xff800000
    v_mov_b32 v56, 0xff800000
    v_mov_b32 v57, 0xff800000
    v_mov_b32 v58, 0xff800000
    v_mov_b32 v59, 0xff800000
    v_mov_b32 v60, 0xff800000
    v_mov_b32 v61, 0xff800000
    v_mov_b32 v62, 0xff800000
    v_mov_b32 v63, 0xff800000
    s_branch Linvb_12
Linv_13:
    s_nop 7
    v_mov_b32 v48, 0xff800000
    v_mov_b32 v49, 0xff800000
    v_mov_b32 v50, 0xff800000
    v_mov_b32 v51, 0xff800000
    v_mov_b32 v52, 0xff800000
    v_mov_b32 v53, 0xff800000
    v_mov_b32 v54, 0xff800000
    v_mov_b32 v55, 0xff800000
    v_mov_b32 v56, 0xff800000
    v_mov_b32 v57, 0xff800000
    v_mov_b32 v58, 0xff800000
    v_mov_b32 v59, 0xff800000
    v_mov_b32 v60, 0xff800000
    v_mov_b32 v61, 0xff800000
    v_mov_b32 v62, 0xff800000
    v_mov_b32 v63, 0xff800000
    s_branch Linvb_14
Linv_15:
    s_nop 7
    v_mov_b32 v48, 0xff800000
    v_mov_b32 v49, 0xff800000
    v_mov_b32 v50, 0xff800000
    v_mov_b32 v51, 0xff800000
    v_mov_b32 v52, 0xff800000
    v_mov_b32 v53, 0xff800000
    v_mov_b32 v54, 0xff800000
    v_mov_b32 v55, 0xff800000
    v_mov_b32 v56, 0xff800000
    v_mov_b32 v57, 0xff800000
    v_mov_b32 v58, 0xff800000
    v_mov_b32 v59, 0xff800000
    v_mov_b32 v60, 0xff800000
    v_mov_b32 v61, 0xff800000
    v_mov_b32 v62, 0xff800000
    v_mov_b32 v63, 0xff800000
    s_branch Linvb_16
Linv_17:
    s_nop 7
    v_mov_b32 v48, 0xff800000
    v_mov_b32 v49, 0xff800000
    v_mov_b32 v50, 0xff800000
    v_mov_b32 v51, 0xff800000
    v_mov_b32 v52, 0xff800000
    v_mov_b32 v53, 0xff800000
    v_mov_b32 v54, 0xff800000
    v_mov_b32 v55, 0xff800000
    v_mov_b32 v56, 0xff800000
    v_mov_b32 v57, 0xff800000
    v_mov_b32 v58, 0xff800000
    v_mov_b32 v59, 0xff800000
    v_mov_b32 v60, 0xff800000
    v_mov_b32 v61, 0xff800000
    v_mov_b32 v62, 0xff800000
    v_mov_b32 v63, 0xff800000
    s_branch Linvb_18
Linv_19:
    s_nop 7
    v_mov_b32 v48, 0xff800000
    v_mov_b32 v49, 0xff800000
    v_mov_b32 v50, 0xff800000
    v_mov_b32 v51, 0xff800000
    v_mov_b32 v52, 0xff800000
    v_mov_b32 v53, 0xff800000
    v_mov_b32 v54, 0xff800000
    v_mov_b32 v55, 0xff800000
    v_mov_b32 v56, 0xff800000
    v_mov_b32 v57, 0xff800000
    v_mov_b32 v58, 0xff800000
    v_mov_b32 v59, 0xff800000
    v_mov_b32 v60, 0xff800000
    v_mov_b32 v61, 0xff800000
    v_mov_b32 v62, 0xff800000
    v_mov_b32 v63, 0xff800000
    s_branch Linvb_20
Linv_21:
    s_nop 7
    v_mov_b32 v48, 0xff800000
    v_mov_b32 v49, 0xff800000
    v_mov_b32 v50, 0xff800000
    v_mov_b32 v51, 0xff800000
    v_mov_b32 v52, 0xff800000
    v_mov_b32 v53, 0xff800000
    v_mov_b32 v54, 0xff800000
    v_mov_b32 v55, 0xff800000
    v_mov_b32 v56, 0xff800000
    v_mov_b32 v57, 0xff800000
    v_mov_b32 v58, 0xff800000
    v_mov_b32 v59, 0xff800000
    v_mov_b32 v60, 0xff800000
    v_mov_b32 v61, 0xff800000
    v_mov_b32 v62, 0xff800000
    v_mov_b32 v63, 0xff800000
    s_branch Linvb_22
Linv_23:
    s_nop 7
    v_mov_b32 v48, 0xff800000
    v_mov_b32 v49, 0xff800000
    v_mov_b32 v50, 0xff800000
    v_mov_b32 v51, 0xff800000
    v_mov_b32 v52, 0xff800000
    v_mov_b32 v53, 0xff800000
    v_mov_b32 v54, 0xff800000
    v_mov_b32 v55, 0xff800000
    v_mov_b32 v56, 0xff800000
    v_mov_b32 v57, 0xff800000
    v_mov_b32 v58, 0xff800000
    v_mov_b32 v59, 0xff800000
    v_mov_b32 v60, 0xff800000
    v_mov_b32 v61, 0xff800000
    v_mov_b32 v62, 0xff800000
    v_mov_b32 v63, 0xff800000
    s_branch Linvb_24
LB_slow:
    s_cmp_lg_u32 s54, 0
    s_cbranch_scc1 LB_fin
    s_mov_b32 s54, 1
    v_add_u32 v96, 4096, v152
    v_add_u32 v97, 4096, v153
    v_mov_b32 v98, 0xff800000
    v_mov_b32 v100, 0xff800000
    s_min_u32 s74, s55, 9
    s_mov_b32 s3, 0
LB_sl:
    ds_read_b128 v[112:115], v96
    ds_read_b64 v[116:117], v97
    v_subrev_u32 v96, 512, v96
    v_subrev_u32 v97, 512, v97
    s_waitcnt lgkmcnt(0)
    v_mfma_f32_32x32x16_bf16 v[0:15], v[112:115], v[144:147], 0
    v_mfma_f32_32x32x16_bf16 v[0:15], v[116:119], v[148:151], v[0:15]
    s_nop 15
    s_cmp_lg_u32 s3, 0
    s_cbranch_scc1 LB_sl1
    v_bitop3_b32 v0, v64, v100, v0 bitop3:0xca
    v_bitop3_b32 v1, v65, v100, v1 bitop3:0xca
    v_bitop3_b32 v2, v66, v100, v2 bitop3:0xca
    v_bitop3_b32 v3, v67, v100, v3 bitop3:0xca
    v_bitop3_b32 v4, v68, v100, v4 bitop3:0xca
    v_bitop3_b32 v5, v69, v100, v5 bitop3:0xca
    v_bitop3_b32 v6, v70, v100, v6 bitop3:0xca
    v_bitop3_b32 v7, v71, v100, v7 bitop3:0xca
    v_bitop3_b32 v8, v72, v100, v8 bitop3:0xca
    v_bitop3_b32 v9, v73, v100, v9 bitop3:0xca
    v_bitop3_b32 v10, v74, v100, v10 bitop3:0xca
    v_bitop3_b32 v11, v75, v100, v11 bitop3:0xca
    v_bitop3_b32 v12, v76, v100, v12 bitop3:0xca
    v_bitop3_b32 v13, v77, v100, v13 bitop3:0xca
    v_bitop3_b32 v14, v78, v100, v14 bitop3:0xca
    v_bitop3_b32 v15, v79, v100, v15 bitop3:0xca
LB_sl1:
    s_cmp_lg_u32 s3, 8
    s_cbranch_scc1 LB_sl2
    v_bitop3_b32 v0, v64, v0, v100 bitop3:0xca
    v_bitop3_b32 v1, v65, v1, v100 bitop3:0xca
    v_bitop3_b32 v2, v66, v2, v100 bitop3:0xca
    v_bitop3_b32 v3, v67, v3, v100 bitop3:0xca
    v_bitop3_b32 v4, v68, v4, v100 bitop3:0xca
    v_bitop3_b32 v5, v69, v5, v100 bitop3:0xca
    v_bitop3_b32 v6, v70, v6, v100 bitop3:0xca
    v_bitop3_b32 v7, v71, v7, v100 bitop3:0xca
    v_bitop3_b32 v8, v72, v8, v100 bitop3:0xca
    v_bitop3_b32 v9, v73, v9, v100 bitop3:0xca
    v_bitop3_b32 v10, v74, v10, v100 bitop3:0xca
    v_bitop3_b32 v11, v75, v11, v100 bitop3:0xca
    v_bitop3_b32 v12, v76, v12, v100 bitop3:0xca
    v_bitop3_b32 v13, v77, v13, v100 bitop3:0xca
    v_bitop3_b32 v14, v78, v14, v100 bitop3:0xca
    v_bitop3_b32 v15, v79, v15, v100 bitop3:0xca
LB_sl2:
    v_max3_f32 v98, v98, v0, v1
    v_max3_f32 v98, v98, v2, v3
    v_max3_f32 v98, v98, v4, v5
    v_max3_f32 v98, v98, v6, v7
    v_max3_f32 v98, v98, v8, v9
    v_max3_f32 v98, v98, v10, v11
    v_max3_f32 v98, v98, v12, v13
    v_max3_f32 v98, v98, v14, v15
    s_add_u32 s3, s3, 1
    s_cmp_lt_u32 s3, s74
    s_cbranch_scc1 LB_sl
    v_mov_b32 v99, v98
    s_nop 1
    v_permlane32_swap_b32 v98, v99
    v_max_f32 v98, v98, v99
    v_sub_f32 v48, 0, v98
    v_sub_f32 v49, 0, v98
    v_sub_f32 v50, 0, v98
    v_sub_f32 v51, 0, v98
    v_sub_f32 v52, 0, v98
    v_sub_f32 v53, 0, v98
    v_sub_f32 v54, 0, v98
    v_sub_f32 v55, 0, v98
    v_sub_f32 v56, 0, v98
    v_sub_f32 v57, 0, v98
    v_sub_f32 v58, 0, v98
    v_sub_f32 v59, 0, v98
    v_sub_f32 v60, 0, v98
    v_sub_f32 v61, 0, v98
    v_sub_f32 v62, 0, v98
    v_sub_f32 v63, 0, v98
    s_cmp_eq_u32 s53, 0
    s_cbranch_scc1 LB_main0
    s_branch LB_main1
Lfin:
Lend:
    s_endpgm
.section .rodata,"a"
.p2align 6
.amdhsa_kernel sequential_preLN__sliding_block__moe_arch_mod__prompt_kernel
  .amdhsa_next_free_vgpr 256
  .amdhsa_next_free_sgpr 102
  .amdhsa_accum_offset 256
  .amdhsa_group_segment_fixed_size 0
  .amdhsa_kernarg_size 88
  .amdhsa_user_sgpr_count 2
  .amdhsa_user_sgpr_kernarg_segment_ptr 1
  .amdhsa_system_sgpr_workgroup_id_x 1
.end_amdhsa_kernel
```
